```python
import torch

def _softmax(x, axis=-1):
    return torch.softmax(x, dim=axis)
def _gelu(x):
    return torch.nn.functional.gelu(x, approximate="tanh")
def _silu(x):
    return torch.nn.functional.silu(x)
def _sigmoid(x):
    return torch.sigmoid(x)
def _layernorm(x, axis=-1, eps=1e-5):
    m = x.mean(dim=axis, keepdim=True)
    v = x.var(dim=axis, keepdim=True, unbiased=False)
    return (x - m) / torch.sqrt(v + eps)
def _scatter_add(tgt, idx, src, axis=0):
    return tgt.clone().index_add_(axis, idx, src)
def _segment_sum(src, seg, n):
    out = torch.zeros((n,) + src.shape[1:], dtype=src.dtype)
    return out.index_add_(0, seg, src)
def _pad(x, pw):
    flat = tuple(v for pair in reversed(pw) for v in pair)
    return torch.nn.functional.pad(x, flat)

kernel_name = 'standalone__deep_cross_wide_deep__recsys'

def setup_inputs():

    _w = (lambda a: (lambda t: t.to(torch.bfloat16) if t.is_floating_point() else t)(torch.as_tensor(a)))
    B, F, D = 4096, 100, 64
    V, Nd = min(100000, 100000), 13
    Din = F * D
    H = 4 * D
    return {
        "idx": _w((lambda lo, hi, *s: torch.randint(lo, hi, s))(0, V, B, F).to(torch.int64)),
        "table": _w((lambda *s: torch.randn(*s, dtype=torch.bfloat16) * 1.6)(V, D) * 0.05),
        "x_wide": _w((lambda *s: torch.randn(*s, dtype=torch.bfloat16) * 1.6)(B, Nd)),
        "w_wide": _w((lambda *s: torch.randn(*s, dtype=torch.bfloat16) * 1.6)(Nd) * 0.05),
        "b_wide": _w((lambda *s: torch.randn(*s, dtype=torch.bfloat16) * 1.6)(1) * 0.01),
        "W1": _w((lambda *s: torch.randn(*s, dtype=torch.bfloat16) * 1.6)(Din, H) * (2.0 / Din) ** 0.5),
        "b1": _w((lambda *s: torch.randn(*s, dtype=torch.bfloat16) * 1.6)(H) * 0.01),
        "W2": _w((lambda *s: torch.randn(*s, dtype=torch.bfloat16) * 1.6)(H) * (1.0 / H) ** 0.5),
        "b2": _w((lambda *s: torch.randn(*s, dtype=torch.bfloat16) * 1.6)(1) * 0.01),
    }

def reference(idx, table, x_wide, w_wide, b_wide, W1, b1, W2, b2):
    emb = table[idx]
    deep_in = emb.reshape(emb.shape[0], -1)
    h = deep_in @ W1 + b1
    h = h * (lambda x, dt: x.to(dt))(h > 0, h.dtype)
    deep_logit = h @ W2 + b2
    wide_logit = x_wide @ w_wide + b_wide
    return _sigmoid(wide_logit + deep_logit)
```

```asm
; @launch grid=(256,1,1) block=(512,1,1) lds=163840
.amdgcn_target "amdgcn-amd-amdhsa--gfx950"
.text
.globl standalone__deep_cross_wide_deep__recsys_kernel
.p2align 8
.type standalone__deep_cross_wide_deep__recsys_kernel,@function
standalone__deep_cross_wide_deep__recsys_kernel:
    s_cmp_ge_u32 s2, 256
    s_cbranch_scc1 L_end
    s_load_dwordx4 s[4:7], s[0:1], 0
    s_load_dwordx2 s[8:9], s[0:1], 40
    s_load_dwordx4 s[56:59], s[0:1], 80
    s_getpc_b64 s[28:29]
    L_pc:
    v_lshrrev_b32 v24, 6, v0
    v_and_b32 v1, 63, v0
    s_and_b32 s31, s2, 7
    v_readfirstlane_b32 s55, v24
    s_lshr_b32 s32, s2, 3
    s_and_b32 s35, s31, 1
    s_nop 1
    s_and_b32 s30, s55, 3
    s_cmp_ge_u32 s55, 4
    s_cbranch_scc0 L_mfma
    s_mul_i32 s33, s31, 25
    s_add_u32 s33, s33, 1
    s_lshr_b32 s33, s33, 1
    s_add_u32 s34, s33, 12
    s_sub_u32 s37, s33, 1
    s_cmp_eq_u32 s35, 1
    s_cselect_b32 s34, s37, s34
    s_mul_i32 s36, s32, 43
    s_lshr_b32 s36, s36, 9
    s_mul_i32 s36, s36, 12
    s_sub_u32 s36, s32, s36
    v_and_b32 v24, 7, v1
    v_add_u32 v25, s36, v24
    v_subrev_u32 v26, 12, v25
    v_min_u32 v25, v25, v26
    v_add_u32 v25, s33, v25
    v_add_u32 v26, s36, v24
    v_add_u32 v26, 8, v26
    v_subrev_u32 v27, 12, v26
    v_min_u32 v26, v26, v27
    v_add_u32 v26, s33, v26
    v_mov_b32 v27, s34
    v_cmp_gt_u32 vcc, 4, v24
    s_lshl_b32 s37, s32, 7
    s_lshl_b32 s41, s30, 1
    v_cndmask_b32 v26, v27, v26, vcc
    v_lshrrev_b32 v27, 3, v1
    v_add_u32 v28, s37, v27
    v_mul_u32_u24 v28, 400, v28
    v_lshl_add_u32 v25, v25, 2, v28
    v_lshl_add_u32 v26, v26, 2, v28
    s_add_u32 s41, s41, s31
    s_add_u32 s41, s41, 1
    s_waitcnt lgkmcnt(0)
    s_mov_b32 s12, s4
    s_and_b32 s13, s5, 0xffff
    s_mov_b32 s14, 1638400
    s_mov_b32 s15, 0x00020000
    s_add_u32 s42, s41, 0
    s_and_b32 s42, s42, 7
    s_mul_i32 s42, s42, 6400
    buffer_load_dword v8, v25, s[12:15], s42 offen
    buffer_load_dword v9, v26, s[12:15], s42 offen
    s_add_u32 s42, s41, 0
    s_and_b32 s42, s42, 7
    s_mul_i32 s42, s42, 6400
    s_add_u32 s42, s42, 3200
    buffer_load_dword v10, v25, s[12:15], s42 offen
    buffer_load_dword v11, v26, s[12:15], s42 offen
    s_add_u32 s42, s41, 1
    s_and_b32 s42, s42, 7
    s_mul_i32 s42, s42, 6400
    buffer_load_dword v12, v25, s[12:15], s42 offen
    buffer_load_dword v13, v26, s[12:15], s42 offen
    s_add_u32 s42, s41, 1
    s_and_b32 s42, s42, 7
    s_mul_i32 s42, s42, 6400
    s_add_u32 s42, s42, 3200
    buffer_load_dword v14, v25, s[12:15], s42 offen
    buffer_load_dword v15, v26, s[12:15], s42 offen
    s_mov_b32 s20, s8
    s_and_b32 s21, s9, 0xffff
    s_mov_b32 s22, 3276800
    s_mov_b32 s23, 0x00020000
    v_bfe_u32 v25, v1, 4, 1
    v_lshlrev_b32 v25, 1, v25
    v_xor_b32 v25, v24, v25
    v_lshlrev_b32 v25, 4, v25
    v_lshl_add_u32 v4, v27, 9, v25
    v_xor_b32 v5, 64, v4
    s_mov_b32 s40, s36
    s_lshl_b32 s44, s30, 7
    s_lshl_b32 s42, s30, 13
    s_add_u32 s42, s42, 65536
    s_lshl_b32 s43, s30, 12
    s_add_u32 s41, s33, s40
    s_lshl_b32 s41, s41, 15
    s_add_u32 s41, s41, s44
    s_add_u32 s40, s40, 1
    s_cmp_eq_u32 s40, 12
    s_cselect_b32 s40, 0, s40
    s_add_u32 m0, s42, 0
    s_add_u32 s45, s41, 0
    buffer_load_dwordx4 v4, s[20:23], s45 offen lds
    s_add_u32 m0, s42, 1024
    s_add_u32 s45, s41, 4096
    buffer_load_dwordx4 v5, s[20:23], s45 offen lds
    s_add_u32 m0, s42, 2048
    s_add_u32 s45, s41, 8192
    buffer_load_dwordx4 v4, s[20:23], s45 offen lds
    s_add_u32 m0, s42, 3072
    s_add_u32 s45, s41, 12288
    buffer_load_dwordx4 v5, s[20:23], s45 offen lds
    s_add_u32 m0, s42, 4096
    s_add_u32 s45, s41, 16384
    buffer_load_dwordx4 v4, s[20:23], s45 offen lds
    s_add_u32 m0, s42, 5120
    s_add_u32 s45, s41, 20480
    buffer_load_dwordx4 v5, s[20:23], s45 offen lds
    s_add_u32 m0, s42, 6144
    s_add_u32 s45, s41, 24576
    buffer_load_dwordx4 v4, s[20:23], s45 offen lds
    s_add_u32 m0, s42, 7168
    s_add_u32 s45, s41, 28672
    buffer_load_dwordx4 v5, s[20:23], s45 offen lds
    s_mov_b32 s16, s6
    s_and_b32 s17, s7, 0xffff
    s_mov_b32 s18, 12800000
    s_mov_b32 s19, 0x00020000
    s_mov_b32 s24, s58
    s_and_b32 s25, s59, 0xffff
    s_mov_b32 s26, 268435456
    s_mov_b32 s27, 0x00020000
    v_lshrrev_b32 v25, 4, v1
    v_xor_b32 v26, v24, v25
    v_lshlrev_b32 v2, 4, v26
    v_xor_b32 v3, 64, v2
    s_waitcnt vmcnt(8)
    v_lshlrev_b32 v8, 7, v8
    v_lshlrev_b32 v9, 7, v9
    v_lshlrev_b32 v10, 7, v10
    v_lshlrev_b32 v11, 7, v11
    v_lshlrev_b32 v12, 7, v12
    v_lshlrev_b32 v13, 7, v13
    v_lshlrev_b32 v14, 7, v14
    v_lshlrev_b32 v15, 7, v15
    s_nop 1
    v_add_u32_dpp v6, v8, v2 row_newbcast:0 row_mask:0xf bank_mask:0x3
    s_add_u32 m0, s43, 0
    v_add_u32_dpp v6, v8, v2 row_newbcast:8 row_mask:0xf bank_mask:0xc
    buffer_load_dwordx4 v6, s[16:19], 0 offen lds
    v_add_u32_dpp v7, v10, v3 row_newbcast:0 row_mask:0xf bank_mask:0x3
    s_add_u32 m0, s43, 1024
    v_add_u32_dpp v7, v10, v3 row_newbcast:8 row_mask:0xf bank_mask:0xc
    buffer_load_dwordx4 v7, s[16:19], 0 offen lds
    v_add_u32_dpp v6, v12, v2 row_newbcast:0 row_mask:0xf bank_mask:0x3
    s_add_u32 m0, s43, 2048
    v_add_u32_dpp v6, v12, v2 row_newbcast:8 row_mask:0xf bank_mask:0xc
    buffer_load_dwordx4 v6, s[16:19], 0 offen lds
    v_add_u32_dpp v7, v14, v3 row_newbcast:0 row_mask:0xf bank_mask:0x3
    s_add_u32 m0, s43, 3072
    v_add_u32_dpp v7, v14, v3 row_newbcast:8 row_mask:0xf bank_mask:0xc
    buffer_load_dwordx4 v7, s[16:19], 0 offen lds
    s_waitcnt vmcnt(4)
    s_barrier
    s_add_u32 s41, s33, s40
    s_lshl_b32 s41, s41, 15
    s_add_u32 s41, s41, s44
    s_add_u32 s40, s40, 1
    s_cmp_eq_u32 s40, 12
    s_cselect_b32 s40, 0, s40
    s_add_u32 m0, s42, 32768
    s_add_u32 s45, s41, 0
    buffer_load_dwordx4 v4, s[20:23], s45 offen lds
    s_add_u32 m0, s42, 33792
    s_add_u32 s45, s41, 4096
    buffer_load_dwordx4 v5, s[20:23], s45 offen lds
    s_add_u32 m0, s42, 34816
    s_add_u32 s45, s41, 8192
    buffer_load_dwordx4 v4, s[20:23], s45 offen lds
    s_add_u32 m0, s42, 35840
    s_add_u32 s45, s41, 12288
    buffer_load_dwordx4 v5, s[20:23], s45 offen lds
    s_add_u32 m0, s42, 36864
    s_add_u32 s45, s41, 16384
    buffer_load_dwordx4 v4, s[20:23], s45 offen lds
    s_add_u32 m0, s42, 37888
    s_add_u32 s45, s41, 20480
    buffer_load_dwordx4 v5, s[20:23], s45 offen lds
    s_add_u32 m0, s42, 38912
    s_add_u32 s45, s41, 24576
    buffer_load_dwordx4 v4, s[20:23], s45 offen lds
    s_add_u32 m0, s42, 39936
    s_add_u32 s45, s41, 28672
    buffer_load_dwordx4 v5, s[20:23], s45 offen lds
    s_add_u32 s41, s33, s40
    s_lshl_b32 s41, s41, 15
    s_add_u32 s41, s41, s44
    s_add_u32 s40, s40, 1
    s_cmp_eq_u32 s40, 12
    s_cselect_b32 s40, 0, s40
    s_add_u32 m0, s42, 65536
    s_add_u32 s45, s41, 0
    buffer_load_dwordx4 v4, s[20:23], s45 offen lds
    s_add_u32 m0, s42, 66560
    s_add_u32 s45, s41, 4096
    buffer_load_dwordx4 v5, s[20:23], s45 offen lds
    s_add_u32 m0, s42, 67584
    s_add_u32 s45, s41, 8192
    buffer_load_dwordx4 v4, s[20:23], s45 offen lds
    s_add_u32 m0, s42, 68608
    s_add_u32 s45, s41, 12288
    buffer_load_dwordx4 v5, s[20:23], s45 offen lds
    s_add_u32 m0, s42, 69632
    s_add_u32 s45, s41, 16384
    buffer_load_dwordx4 v4, s[20:23], s45 offen lds
    s_add_u32 m0, s42, 70656
    s_add_u32 s45, s41, 20480
    buffer_load_dwordx4 v5, s[20:23], s45 offen lds
    s_add_u32 m0, s42, 71680
    s_add_u32 s45, s41, 24576
    buffer_load_dwordx4 v4, s[20:23], s45 offen lds
    s_add_u32 m0, s42, 72704
    s_add_u32 s45, s41, 28672
    buffer_load_dwordx4 v5, s[20:23], s45 offen lds
    v_add_u32_dpp v6, v8, v2 row_newbcast:1 row_mask:0xf bank_mask:0x3
    s_add_u32 m0, s43, 16384
    v_add_u32_dpp v6, v8, v2 row_newbcast:9 row_mask:0xf bank_mask:0xc
    buffer_load_dwordx4 v6, s[16:19], 0 offen lds
    v_add_u32_dpp v7, v10, v3 row_newbcast:1 row_mask:0xf bank_mask:0x3
    s_add_u32 m0, s43, 17408
    v_add_u32_dpp v7, v10, v3 row_newbcast:9 row_mask:0xf bank_mask:0xc
    buffer_load_dwordx4 v7, s[16:19], 0 offen lds
    v_add_u32_dpp v6, v12, v2 row_newbcast:1 row_mask:0xf bank_mask:0x3
    s_add_u32 m0, s43, 18432
    v_add_u32_dpp v6, v12, v2 row_newbcast:9 row_mask:0xf bank_mask:0xc
    buffer_load_dwordx4 v6, s[16:19], 0 offen lds
    v_add_u32_dpp v7, v14, v3 row_newbcast:1 row_mask:0xf bank_mask:0x3
    s_add_u32 m0, s43, 19456
    v_add_u32_dpp v7, v14, v3 row_newbcast:9 row_mask:0xf bank_mask:0xc
    buffer_load_dwordx4 v7, s[16:19], 0 offen lds
    s_waitcnt vmcnt(20)
    s_waitcnt vmcnt(12)
    s_barrier
    v_add_u32_dpp v6, v8, v2 row_newbcast:2 row_mask:0xf bank_mask:0x3
    s_add_u32 m0, s43, 32768
    v_add_u32_dpp v6, v8, v2 row_newbcast:10 row_mask:0xf bank_mask:0xc
    buffer_load_dwordx4 v6, s[16:19], 0 offen lds
    v_add_u32_dpp v7, v10, v3 row_newbcast:2 row_mask:0xf bank_mask:0x3
    s_add_u32 m0, s43, 33792
    v_add_u32_dpp v7, v10, v3 row_newbcast:10 row_mask:0xf bank_mask:0xc
    buffer_load_dwordx4 v7, s[16:19], 0 offen lds
    v_add_u32_dpp v6, v12, v2 row_newbcast:2 row_mask:0xf bank_mask:0x3
    s_add_u32 m0, s43, 34816
    v_add_u32_dpp v6, v12, v2 row_newbcast:10 row_mask:0xf bank_mask:0xc
    buffer_load_dwordx4 v6, s[16:19], 0 offen lds
    v_add_u32_dpp v7, v14, v3 row_newbcast:2 row_mask:0xf bank_mask:0x3
    s_add_u32 m0, s43, 35840
    v_add_u32_dpp v7, v14, v3 row_newbcast:10 row_mask:0xf bank_mask:0xc
    buffer_load_dwordx4 v7, s[16:19], 0 offen lds
    s_add_u32 s41, s33, s40
    s_lshl_b32 s41, s41, 15
    s_add_u32 s41, s41, s44
    s_add_u32 s40, s40, 1
    s_cmp_eq_u32 s40, 12
    s_cselect_b32 s40, 0, s40
    s_add_u32 m0, s42, 0
    s_add_u32 s45, s41, 0
    buffer_load_dwordx4 v4, s[20:23], s45 offen lds
    s_add_u32 m0, s42, 1024
    s_add_u32 s45, s41, 4096
    buffer_load_dwordx4 v5, s[20:23], s45 offen lds
    s_add_u32 m0, s42, 2048
    s_add_u32 s45, s41, 8192
    buffer_load_dwordx4 v4, s[20:23], s45 offen lds
    s_add_u32 m0, s42, 3072
    s_add_u32 s45, s41, 12288
    buffer_load_dwordx4 v5, s[20:23], s45 offen lds
    s_add_u32 m0, s42, 4096
    s_add_u32 s45, s41, 16384
    buffer_load_dwordx4 v4, s[20:23], s45 offen lds
    s_add_u32 m0, s42, 5120
    s_add_u32 s45, s41, 20480
    buffer_load_dwordx4 v5, s[20:23], s45 offen lds
    s_add_u32 m0, s42, 6144
    s_add_u32 s45, s41, 24576
    buffer_load_dwordx4 v4, s[20:23], s45 offen lds
    s_add_u32 m0, s42, 7168
    s_add_u32 s45, s41, 28672
    buffer_load_dwordx4 v5, s[20:23], s45 offen lds
    v_add_u32_dpp v6, v8, v2 row_newbcast:3 row_mask:0xf bank_mask:0x3
    s_add_u32 m0, s43, 49152
    v_add_u32_dpp v6, v8, v2 row_newbcast:11 row_mask:0xf bank_mask:0xc
    buffer_load_dwordx4 v6, s[16:19], 0 offen lds
    v_add_u32_dpp v7, v10, v3 row_newbcast:3 row_mask:0xf bank_mask:0x3
    s_add_u32 m0, s43, 50176
    v_add_u32_dpp v7, v10, v3 row_newbcast:11 row_mask:0xf bank_mask:0xc
    buffer_load_dwordx4 v7, s[16:19], 0 offen lds
    v_add_u32_dpp v6, v12, v2 row_newbcast:3 row_mask:0xf bank_mask:0x3
    s_add_u32 m0, s43, 51200
    v_add_u32_dpp v6, v12, v2 row_newbcast:11 row_mask:0xf bank_mask:0xc
    buffer_load_dwordx4 v6, s[16:19], 0 offen lds
    v_add_u32_dpp v7, v14, v3 row_newbcast:3 row_mask:0xf bank_mask:0x3
    s_add_u32 m0, s43, 52224
    v_add_u32_dpp v7, v14, v3 row_newbcast:11 row_mask:0xf bank_mask:0xc
    buffer_load_dwordx4 v7, s[16:19], 0 offen lds
    s_waitcnt vmcnt(16)
    s_barrier
    s_add_u32 s41, s33, s40
    s_lshl_b32 s41, s41, 15
    s_add_u32 s41, s41, s44
    s_add_u32 s40, s40, 1
    s_cmp_eq_u32 s40, 12
    s_cselect_b32 s40, 0, s40
    s_add_u32 m0, s42, 32768
    s_add_u32 s45, s41, 0
    buffer_load_dwordx4 v4, s[20:23], s45 offen lds
    s_add_u32 m0, s42, 33792
    s_add_u32 s45, s41, 4096
    buffer_load_dwordx4 v5, s[20:23], s45 offen lds
    s_add_u32 m0, s42, 34816
    s_add_u32 s45, s41, 8192
    buffer_load_dwordx4 v4, s[20:23], s45 offen lds
    s_add_u32 m0, s42, 35840
    s_add_u32 s45, s41, 12288
    buffer_load_dwordx4 v5, s[20:23], s45 offen lds
    s_add_u32 m0, s42, 36864
    s_add_u32 s45, s41, 16384
    buffer_load_dwordx4 v4, s[20:23], s45 offen lds
    s_add_u32 m0, s42, 37888
    s_add_u32 s45, s41, 20480
    buffer_load_dwordx4 v5, s[20:23], s45 offen lds
    s_add_u32 m0, s42, 38912
    s_add_u32 s45, s41, 24576
    buffer_load_dwordx4 v4, s[20:23], s45 offen lds
    s_add_u32 m0, s42, 39936
    s_add_u32 s45, s41, 28672
    buffer_load_dwordx4 v5, s[20:23], s45 offen lds
    s_waitcnt vmcnt(20)
    s_waitcnt vmcnt(12)
    s_barrier
    v_add_u32_dpp v6, v8, v2 row_newbcast:4 row_mask:0xf bank_mask:0x3
    s_add_u32 m0, s43, 0
    v_add_u32_dpp v6, v8, v2 row_newbcast:12 row_mask:0xf bank_mask:0xc
    buffer_load_dwordx4 v6, s[16:19], 0 offen lds
    v_add_u32_dpp v7, v10, v3 row_newbcast:4 row_mask:0xf bank_mask:0x3
    s_add_u32 m0, s43, 1024
    v_add_u32_dpp v7, v10, v3 row_newbcast:12 row_mask:0xf bank_mask:0xc
    buffer_load_dwordx4 v7, s[16:19], 0 offen lds
    v_add_u32_dpp v6, v12, v2 row_newbcast:4 row_mask:0xf bank_mask:0x3
    s_add_u32 m0, s43, 2048
    v_add_u32_dpp v6, v12, v2 row_newbcast:12 row_mask:0xf bank_mask:0xc
    buffer_load_dwordx4 v6, s[16:19], 0 offen lds
    v_add_u32_dpp v7, v14, v3 row_newbcast:4 row_mask:0xf bank_mask:0x3
    s_add_u32 m0, s43, 3072
    v_add_u32_dpp v7, v14, v3 row_newbcast:12 row_mask:0xf bank_mask:0xc
    buffer_load_dwordx4 v7, s[16:19], 0 offen lds
    s_add_u32 s41, s33, s40
    s_lshl_b32 s41, s41, 15
    s_add_u32 s41, s41, s44
    s_add_u32 s40, s40, 1
    s_cmp_eq_u32 s40, 12
    s_cselect_b32 s40, 0, s40
    s_add_u32 m0, s42, 65536
    s_add_u32 s45, s41, 0
    buffer_load_dwordx4 v4, s[20:23], s45 offen lds
    s_add_u32 m0, s42, 66560
    s_add_u32 s45, s41, 4096
    buffer_load_dwordx4 v5, s[20:23], s45 offen lds
    s_add_u32 m0, s42, 67584
    s_add_u32 s45, s41, 8192
    buffer_load_dwordx4 v4, s[20:23], s45 offen lds
    s_add_u32 m0, s42, 68608
    s_add_u32 s45, s41, 12288
    buffer_load_dwordx4 v5, s[20:23], s45 offen lds
    s_add_u32 m0, s42, 69632
    s_add_u32 s45, s41, 16384
    buffer_load_dwordx4 v4, s[20:23], s45 offen lds
    s_add_u32 m0, s42, 70656
    s_add_u32 s45, s41, 20480
    buffer_load_dwordx4 v5, s[20:23], s45 offen lds
    s_add_u32 m0, s42, 71680
    s_add_u32 s45, s41, 24576
    buffer_load_dwordx4 v4, s[20:23], s45 offen lds
    s_add_u32 m0, s42, 72704
    s_add_u32 s45, s41, 28672
    buffer_load_dwordx4 v5, s[20:23], s45 offen lds
    s_waitcnt vmcnt(20)
    s_waitcnt vmcnt(12)
    s_barrier
    v_add_u32_dpp v6, v8, v2 row_newbcast:5 row_mask:0xf bank_mask:0x3
    s_add_u32 m0, s43, 16384
    v_add_u32_dpp v6, v8, v2 row_newbcast:13 row_mask:0xf bank_mask:0xc
    buffer_load_dwordx4 v6, s[16:19], 0 offen lds
    v_add_u32_dpp v7, v10, v3 row_newbcast:5 row_mask:0xf bank_mask:0x3
    s_add_u32 m0, s43, 17408
    v_add_u32_dpp v7, v10, v3 row_newbcast:13 row_mask:0xf bank_mask:0xc
    buffer_load_dwordx4 v7, s[16:19], 0 offen lds
    v_add_u32_dpp v6, v12, v2 row_newbcast:5 row_mask:0xf bank_mask:0x3
    s_add_u32 m0, s43, 18432
    v_add_u32_dpp v6, v12, v2 row_newbcast:13 row_mask:0xf bank_mask:0xc
    buffer_load_dwordx4 v6, s[16:19], 0 offen lds
    v_add_u32_dpp v7, v14, v3 row_newbcast:5 row_mask:0xf bank_mask:0x3
    s_add_u32 m0, s43, 19456
    v_add_u32_dpp v7, v14, v3 row_newbcast:13 row_mask:0xf bank_mask:0xc
    buffer_load_dwordx4 v7, s[16:19], 0 offen lds
    s_add_u32 s41, s33, s40
    s_lshl_b32 s41, s41, 15
    s_add_u32 s41, s41, s44
    s_add_u32 s40, s40, 1
    s_cmp_eq_u32 s40, 12
    s_cselect_b32 s40, 0, s40
    s_add_u32 m0, s42, 0
    s_add_u32 s45, s41, 0
    buffer_load_dwordx4 v4, s[20:23], s45 offen lds
    s_add_u32 m0, s42, 1024
    s_add_u32 s45, s41, 4096
    buffer_load_dwordx4 v5, s[20:23], s45 offen lds
    s_add_u32 m0, s42, 2048
    s_add_u32 s45, s41, 8192
    buffer_load_dwordx4 v4, s[20:23], s45 offen lds
    s_add_u32 m0, s42, 3072
    s_add_u32 s45, s41, 12288
    buffer_load_dwordx4 v5, s[20:23], s45 offen lds
    s_add_u32 m0, s42, 4096
    s_add_u32 s45, s41, 16384
    buffer_load_dwordx4 v4, s[20:23], s45 offen lds
    s_add_u32 m0, s42, 5120
    s_add_u32 s45, s41, 20480
    buffer_load_dwordx4 v5, s[20:23], s45 offen lds
    s_add_u32 m0, s42, 6144
    s_add_u32 s45, s41, 24576
    buffer_load_dwordx4 v4, s[20:23], s45 offen lds
    s_add_u32 m0, s42, 7168
    s_add_u32 s45, s41, 28672
    buffer_load_dwordx4 v5, s[20:23], s45 offen lds
    s_waitcnt vmcnt(20)
    s_waitcnt vmcnt(12)
    s_barrier
    v_add_u32_dpp v6, v8, v2 row_newbcast:6 row_mask:0xf bank_mask:0x3
    s_add_u32 m0, s43, 32768
    v_add_u32_dpp v6, v8, v2 row_newbcast:14 row_mask:0xf bank_mask:0xc
    buffer_load_dwordx4 v6, s[16:19], 0 offen lds
    v_add_u32_dpp v7, v10, v3 row_newbcast:6 row_mask:0xf bank_mask:0x3
    s_add_u32 m0, s43, 33792
    v_add_u32_dpp v7, v10, v3 row_newbcast:14 row_mask:0xf bank_mask:0xc
    buffer_load_dwordx4 v7, s[16:19], 0 offen lds
    v_add_u32_dpp v6, v12, v2 row_newbcast:6 row_mask:0xf bank_mask:0x3
    s_add_u32 m0, s43, 34816
    v_add_u32_dpp v6, v12, v2 row_newbcast:14 row_mask:0xf bank_mask:0xc
    buffer_load_dwordx4 v6, s[16:19], 0 offen lds
    v_add_u32_dpp v7, v14, v3 row_newbcast:6 row_mask:0xf bank_mask:0x3
    s_add_u32 m0, s43, 35840
    v_add_u32_dpp v7, v14, v3 row_newbcast:14 row_mask:0xf bank_mask:0xc
    buffer_load_dwordx4 v7, s[16:19], 0 offen lds
    s_add_u32 s41, s33, s40
    s_lshl_b32 s41, s41, 15
    s_add_u32 s41, s41, s44
    s_add_u32 s40, s40, 1
    s_cmp_eq_u32 s40, 12
    s_cselect_b32 s40, 0, s40
    s_add_u32 m0, s42, 32768
    s_add_u32 s45, s41, 0
    buffer_load_dwordx4 v4, s[20:23], s45 offen lds
    s_add_u32 m0, s42, 33792
    s_add_u32 s45, s41, 4096
    buffer_load_dwordx4 v5, s[20:23], s45 offen lds
    s_add_u32 m0, s42, 34816
    s_add_u32 s45, s41, 8192
    buffer_load_dwordx4 v4, s[20:23], s45 offen lds
    s_add_u32 m0, s42, 35840
    s_add_u32 s45, s41, 12288
    buffer_load_dwordx4 v5, s[20:23], s45 offen lds
    s_add_u32 m0, s42, 36864
    s_add_u32 s45, s41, 16384
    buffer_load_dwordx4 v4, s[20:23], s45 offen lds
    s_add_u32 m0, s42, 37888
    s_add_u32 s45, s41, 20480
    buffer_load_dwordx4 v5, s[20:23], s45 offen lds
    s_add_u32 m0, s42, 38912
    s_add_u32 s45, s41, 24576
    buffer_load_dwordx4 v4, s[20:23], s45 offen lds
    s_add_u32 m0, s42, 39936
    s_add_u32 s45, s41, 28672
    buffer_load_dwordx4 v5, s[20:23], s45 offen lds
    s_waitcnt vmcnt(20)
    s_waitcnt vmcnt(12)
    s_barrier
    v_add_u32_dpp v6, v8, v2 row_newbcast:7 row_mask:0xf bank_mask:0x3
    s_add_u32 m0, s43, 49152
    v_add_u32_dpp v6, v8, v2 row_newbcast:15 row_mask:0xf bank_mask:0xc
    buffer_load_dwordx4 v6, s[16:19], 0 offen lds
    v_add_u32_dpp v7, v10, v3 row_newbcast:7 row_mask:0xf bank_mask:0x3
    s_add_u32 m0, s43, 50176
    v_add_u32_dpp v7, v10, v3 row_newbcast:15 row_mask:0xf bank_mask:0xc
    buffer_load_dwordx4 v7, s[16:19], 0 offen lds
    v_add_u32_dpp v6, v12, v2 row_newbcast:7 row_mask:0xf bank_mask:0x3
    s_add_u32 m0, s43, 51200
    v_add_u32_dpp v6, v12, v2 row_newbcast:15 row_mask:0xf bank_mask:0xc
    buffer_load_dwordx4 v6, s[16:19], 0 offen lds
    v_add_u32_dpp v7, v14, v3 row_newbcast:7 row_mask:0xf bank_mask:0x3
    s_add_u32 m0, s43, 52224
    v_add_u32_dpp v7, v14, v3 row_newbcast:15 row_mask:0xf bank_mask:0xc
    buffer_load_dwordx4 v7, s[16:19], 0 offen lds
    s_add_u32 s41, s33, s40
    s_lshl_b32 s41, s41, 15
    s_add_u32 s41, s41, s44
    s_add_u32 s40, s40, 1
    s_cmp_eq_u32 s40, 12
    s_cselect_b32 s40, 0, s40
    s_add_u32 m0, s42, 65536
    s_add_u32 s45, s41, 0
    buffer_load_dwordx4 v4, s[20:23], s45 offen lds
    s_add_u32 m0, s42, 66560
    s_add_u32 s45, s41, 4096
    buffer_load_dwordx4 v5, s[20:23], s45 offen lds
    s_add_u32 m0, s42, 67584
    s_add_u32 s45, s41, 8192
    buffer_load_dwordx4 v4, s[20:23], s45 offen lds
    s_add_u32 m0, s42, 68608
    s_add_u32 s45, s41, 12288
    buffer_load_dwordx4 v5, s[20:23], s45 offen lds
    s_add_u32 m0, s42, 69632
    s_add_u32 s45, s41, 16384
    buffer_load_dwordx4 v4, s[20:23], s45 offen lds
    s_add_u32 m0, s42, 70656
    s_add_u32 s45, s41, 20480
    buffer_load_dwordx4 v5, s[20:23], s45 offen lds
    s_add_u32 m0, s42, 71680
    s_add_u32 s45, s41, 24576
    buffer_load_dwordx4 v4, s[20:23], s45 offen lds
    s_add_u32 m0, s42, 72704
    s_add_u32 s45, s41, 28672
    buffer_load_dwordx4 v5, s[20:23], s45 offen lds
    s_waitcnt vmcnt(20)
    s_waitcnt vmcnt(12)
    s_barrier
    v_add_u32_dpp v6, v9, v2 row_newbcast:0 row_mask:0xf bank_mask:0x3
    s_add_u32 m0, s43, 0
    v_add_u32_dpp v6, v9, v2 row_newbcast:8 row_mask:0xf bank_mask:0xc
    buffer_load_dwordx4 v6, s[16:19], 0 offen lds
    v_add_u32_dpp v7, v11, v3 row_newbcast:0 row_mask:0xf bank_mask:0x3
    s_add_u32 m0, s43, 1024
    v_add_u32_dpp v7, v11, v3 row_newbcast:8 row_mask:0xf bank_mask:0xc
    buffer_load_dwordx4 v7, s[16:19], 0 offen lds
    v_add_u32_dpp v6, v13, v2 row_newbcast:0 row_mask:0xf bank_mask:0x3
    s_add_u32 m0, s43, 2048
    v_add_u32_dpp v6, v13, v2 row_newbcast:8 row_mask:0xf bank_mask:0xc
    buffer_load_dwordx4 v6, s[16:19], 0 offen lds
    v_add_u32_dpp v7, v15, v3 row_newbcast:0 row_mask:0xf bank_mask:0x3
    s_add_u32 m0, s43, 3072
    v_add_u32_dpp v7, v15, v3 row_newbcast:8 row_mask:0xf bank_mask:0xc
    buffer_load_dwordx4 v7, s[16:19], 0 offen lds
    s_add_u32 s41, s33, s40
    s_lshl_b32 s41, s41, 15
    s_add_u32 s41, s41, s44
    s_add_u32 s40, s40, 1
    s_cmp_eq_u32 s40, 12
    s_cselect_b32 s40, 0, s40
    s_add_u32 m0, s42, 0
    s_add_u32 s45, s41, 0
    buffer_load_dwordx4 v4, s[20:23], s45 offen lds
    s_add_u32 m0, s42, 1024
    s_add_u32 s45, s41, 4096
    buffer_load_dwordx4 v5, s[20:23], s45 offen lds
    s_add_u32 m0, s42, 2048
    s_add_u32 s45, s41, 8192
    buffer_load_dwordx4 v4, s[20:23], s45 offen lds
    s_add_u32 m0, s42, 3072
    s_add_u32 s45, s41, 12288
    buffer_load_dwordx4 v5, s[20:23], s45 offen lds
    s_add_u32 m0, s42, 4096
    s_add_u32 s45, s41, 16384
    buffer_load_dwordx4 v4, s[20:23], s45 offen lds
    s_add_u32 m0, s42, 5120
    s_add_u32 s45, s41, 20480
    buffer_load_dwordx4 v5, s[20:23], s45 offen lds
    s_add_u32 m0, s42, 6144
    s_add_u32 s45, s41, 24576
    buffer_load_dwordx4 v4, s[20:23], s45 offen lds
    s_add_u32 m0, s42, 7168
    s_add_u32 s45, s41, 28672
    buffer_load_dwordx4 v5, s[20:23], s45 offen lds
    s_waitcnt vmcnt(20)
    s_waitcnt vmcnt(12)
    s_barrier
    v_add_u32_dpp v6, v9, v2 row_newbcast:1 row_mask:0xf bank_mask:0x3
    s_add_u32 m0, s43, 16384
    v_add_u32_dpp v6, v9, v2 row_newbcast:9 row_mask:0xf bank_mask:0xc
    buffer_load_dwordx4 v6, s[16:19], 0 offen lds
    v_add_u32_dpp v7, v11, v3 row_newbcast:1 row_mask:0xf bank_mask:0x3
    s_add_u32 m0, s43, 17408
    v_add_u32_dpp v7, v11, v3 row_newbcast:9 row_mask:0xf bank_mask:0xc
    buffer_load_dwordx4 v7, s[16:19], 0 offen lds
    v_add_u32_dpp v6, v13, v2 row_newbcast:1 row_mask:0xf bank_mask:0x3
    s_add_u32 m0, s43, 18432
    v_add_u32_dpp v6, v13, v2 row_newbcast:9 row_mask:0xf bank_mask:0xc
    buffer_load_dwordx4 v6, s[16:19], 0 offen lds
    v_add_u32_dpp v7, v15, v3 row_newbcast:1 row_mask:0xf bank_mask:0x3
    s_add_u32 m0, s43, 19456
    v_add_u32_dpp v7, v15, v3 row_newbcast:9 row_mask:0xf bank_mask:0xc
    buffer_load_dwordx4 v7, s[16:19], 0 offen lds
    s_add_u32 s41, s33, s40
    s_lshl_b32 s41, s41, 15
    s_add_u32 s41, s41, s44
    s_add_u32 s40, s40, 1
    s_cmp_eq_u32 s40, 12
    s_cselect_b32 s40, 0, s40
    s_add_u32 m0, s42, 32768
    s_add_u32 s45, s41, 0
    buffer_load_dwordx4 v4, s[20:23], s45 offen lds
    s_add_u32 m0, s42, 33792
    s_add_u32 s45, s41, 4096
    buffer_load_dwordx4 v5, s[20:23], s45 offen lds
    s_add_u32 m0, s42, 34816
    s_add_u32 s45, s41, 8192
    buffer_load_dwordx4 v4, s[20:23], s45 offen lds
    s_add_u32 m0, s42, 35840
    s_add_u32 s45, s41, 12288
    buffer_load_dwordx4 v5, s[20:23], s45 offen lds
    s_add_u32 m0, s42, 36864
    s_add_u32 s45, s41, 16384
    buffer_load_dwordx4 v4, s[20:23], s45 offen lds
    s_add_u32 m0, s42, 37888
    s_add_u32 s45, s41, 20480
    buffer_load_dwordx4 v5, s[20:23], s45 offen lds
    s_add_u32 m0, s42, 38912
    s_add_u32 s45, s41, 24576
    buffer_load_dwordx4 v4, s[20:23], s45 offen lds
    s_add_u32 m0, s42, 39936
    s_add_u32 s45, s41, 28672
    buffer_load_dwordx4 v5, s[20:23], s45 offen lds
    s_waitcnt vmcnt(20)
    s_waitcnt vmcnt(12)
    s_barrier
    v_add_u32_dpp v6, v9, v2 row_newbcast:2 row_mask:0xf bank_mask:0x3
    s_add_u32 m0, s43, 32768
    v_add_u32_dpp v6, v9, v2 row_newbcast:10 row_mask:0xf bank_mask:0xc
    buffer_load_dwordx4 v6, s[16:19], 0 offen lds
    v_add_u32_dpp v7, v11, v3 row_newbcast:2 row_mask:0xf bank_mask:0x3
    s_add_u32 m0, s43, 33792
    v_add_u32_dpp v7, v11, v3 row_newbcast:10 row_mask:0xf bank_mask:0xc
    buffer_load_dwordx4 v7, s[16:19], 0 offen lds
    v_add_u32_dpp v6, v13, v2 row_newbcast:2 row_mask:0xf bank_mask:0x3
    s_add_u32 m0, s43, 34816
    v_add_u32_dpp v6, v13, v2 row_newbcast:10 row_mask:0xf bank_mask:0xc
    buffer_load_dwordx4 v6, s[16:19], 0 offen lds
    v_add_u32_dpp v7, v15, v3 row_newbcast:2 row_mask:0xf bank_mask:0x3
    s_add_u32 m0, s43, 35840
    v_add_u32_dpp v7, v15, v3 row_newbcast:10 row_mask:0xf bank_mask:0xc
    buffer_load_dwordx4 v7, s[16:19], 0 offen lds
    s_add_u32 s41, s33, s40
    s_lshl_b32 s41, s41, 15
    s_add_u32 s41, s41, s44
    s_add_u32 s40, s40, 1
    s_cmp_eq_u32 s40, 12
    s_cselect_b32 s40, 0, s40
    s_add_u32 m0, s42, 65536
    s_add_u32 s45, s41, 0
    buffer_load_dwordx4 v4, s[20:23], s45 offen lds
    s_add_u32 m0, s42, 66560
    s_add_u32 s45, s41, 4096
    buffer_load_dwordx4 v5, s[20:23], s45 offen lds
    s_add_u32 m0, s42, 67584
    s_add_u32 s45, s41, 8192
    buffer_load_dwordx4 v4, s[20:23], s45 offen lds
    s_add_u32 m0, s42, 68608
    s_add_u32 s45, s41, 12288
    buffer_load_dwordx4 v5, s[20:23], s45 offen lds
    s_add_u32 m0, s42, 69632
    s_add_u32 s45, s41, 16384
    buffer_load_dwordx4 v4, s[20:23], s45 offen lds
    s_add_u32 m0, s42, 70656
    s_add_u32 s45, s41, 20480
    buffer_load_dwordx4 v5, s[20:23], s45 offen lds
    s_add_u32 m0, s42, 71680
    s_add_u32 s45, s41, 24576
    buffer_load_dwordx4 v4, s[20:23], s45 offen lds
    s_add_u32 m0, s42, 72704
    s_add_u32 s45, s41, 28672
    buffer_load_dwordx4 v5, s[20:23], s45 offen lds
    s_waitcnt vmcnt(20)
    s_waitcnt vmcnt(12)
    s_barrier
    v_add_u32_dpp v6, v9, v2 row_newbcast:3 row_mask:0xf bank_mask:0x3
    s_add_u32 m0, s43, 49152
    v_add_u32_dpp v6, v9, v2 row_newbcast:11 row_mask:0xf bank_mask:0xc
    buffer_load_dwordx4 v6, s[16:19], 0 offen lds
    v_add_u32_dpp v7, v11, v3 row_newbcast:3 row_mask:0xf bank_mask:0x3
    s_add_u32 m0, s43, 50176
    v_add_u32_dpp v7, v11, v3 row_newbcast:11 row_mask:0xf bank_mask:0xc
    buffer_load_dwordx4 v7, s[16:19], 0 offen lds
    v_add_u32_dpp v6, v13, v2 row_newbcast:3 row_mask:0xf bank_mask:0x3
    s_add_u32 m0, s43, 51200
    v_add_u32_dpp v6, v13, v2 row_newbcast:11 row_mask:0xf bank_mask:0xc
    buffer_load_dwordx4 v6, s[16:19], 0 offen lds
    v_add_u32_dpp v7, v15, v3 row_newbcast:3 row_mask:0xf bank_mask:0x3
    s_add_u32 m0, s43, 52224
    v_add_u32_dpp v7, v15, v3 row_newbcast:11 row_mask:0xf bank_mask:0xc
    buffer_load_dwordx4 v7, s[16:19], 0 offen lds
    s_lshl_b32 s41, s34, 15
    s_lshl_b32 s45, s35, 14
    s_add_u32 s41, s41, s45
    s_add_u32 s41, s41, s44
    s_add_u32 m0, s42, 0
    s_add_u32 s45, s41, 0
    buffer_load_dwordx4 v4, s[20:23], s45 offen lds
    s_add_u32 m0, s42, 1024
    s_add_u32 s45, s41, 4096
    buffer_load_dwordx4 v5, s[20:23], s45 offen lds
    s_add_u32 m0, s42, 2048
    s_add_u32 s45, s41, 8192
    buffer_load_dwordx4 v4, s[20:23], s45 offen lds
    s_add_u32 m0, s42, 3072
    s_add_u32 s45, s41, 12288
    buffer_load_dwordx4 v5, s[20:23], s45 offen lds
    s_waitcnt vmcnt(16)
    s_waitcnt vmcnt(8)
    s_barrier
    v_add_u32_dpp v6, v9, v2 row_newbcast:4 row_mask:0xf bank_mask:0x3
    s_add_u32 m0, s43, 0
    v_add_u32_dpp v6, v9, v2 row_newbcast:12 row_mask:0xf bank_mask:0xc
    buffer_load_dwordx4 v6, s[16:19], 0 offen lds
    v_add_u32_dpp v7, v11, v3 row_newbcast:4 row_mask:0xf bank_mask:0x3
    s_add_u32 m0, s43, 1024
    v_add_u32_dpp v7, v11, v3 row_newbcast:12 row_mask:0xf bank_mask:0xc
    buffer_load_dwordx4 v7, s[16:19], 0 offen lds
    v_add_u32_dpp v6, v13, v2 row_newbcast:4 row_mask:0xf bank_mask:0x3
    s_add_u32 m0, s43, 2048
    v_add_u32_dpp v6, v13, v2 row_newbcast:12 row_mask:0xf bank_mask:0xc
    buffer_load_dwordx4 v6, s[16:19], 0 offen lds
    v_add_u32_dpp v7, v15, v3 row_newbcast:4 row_mask:0xf bank_mask:0x3
    s_add_u32 m0, s43, 3072
    v_add_u32_dpp v7, v15, v3 row_newbcast:12 row_mask:0xf bank_mask:0xc
    buffer_load_dwordx4 v7, s[16:19], 0 offen lds
    s_waitcnt vmcnt(8)
    s_waitcnt vmcnt(4)
    s_waitcnt vmcnt(0)
    s_barrier
    s_waitcnt vmcnt(0)
    s_load_dwordx4 s[4:7], s[0:1], 16
    s_load_dwordx2 s[8:9], s[0:1], 32
    s_load_dwordx8 s[68:75], s[0:1], 48
    v_lshrrev_b32 v3, 4, v1
    v_lshlrev_b32 v4, 3, v3
    v_and_b32 v5, 15, v1
    s_lshl_b32 s33, s2, 4
    v_add_u32 v6, s33, v5
    v_mul_u32_u24 v7, 26, v6
    v_lshl_add_u32 v7, v3, 1, v7
    v_lshlrev_b32 v8, 1, v3
    v_mov_b32 v9, 0
    v_lshlrev_b32 v2, 4, v1
    v_and_b32 v10, 7, v1
    v_lshlrev_b32 v10, 2, v10
    s_waitcnt lgkmcnt(0)
    s_mov_b32 s12, s68
    s_and_b32 s13, s69, 0xffff
    s_mov_b32 s14, 512
    s_mov_b32 s15, 0x00020000
    s_mov_b32 s16, s70
    s_and_b32 s17, s71, 0xffff
    s_mov_b32 s18, 512
    s_mov_b32 s19, 0x00020000
    s_mov_b32 s20, s4
    s_and_b32 s21, s5, 0xffff
    s_mov_b32 s22, 106496
    s_mov_b32 s23, 0x00020000
    s_mov_b32 s48, s6
    s_and_b32 s49, s7, 0xffff
    s_mov_b32 s50, 26
    s_mov_b32 s51, 0x00020000
    s_mov_b32 s60, s8
    s_and_b32 s61, s9, 0xffff
    s_mov_b32 s62, 2
    s_mov_b32 s63, 0x00020000
    s_mov_b32 s64, s72
    s_and_b32 s65, s73, 0xffff
    s_mov_b32 s66, 2
    s_mov_b32 s67, 0x00020000
    s_mov_b32 s76, s74
    s_and_b32 s77, s75, 0xffff
    s_mov_b32 s78, 8192
    s_mov_b32 s79, 0x00020000
    s_lshl_b32 s32, s30, 7
    buffer_load_dwordx2 v[96:97], v4, s[12:15], s32 offen offset:0
    buffer_load_dwordx2 v[104:105], v4, s[16:19], s32 offen offset:0
    buffer_load_dwordx2 v[98:99], v4, s[12:15], s32 offen offset:32
    buffer_load_dwordx2 v[106:107], v4, s[16:19], s32 offen offset:32
    buffer_load_dwordx2 v[100:101], v4, s[12:15], s32 offen offset:64
    buffer_load_dwordx2 v[108:109], v4, s[16:19], s32 offen offset:64
    buffer_load_dwordx2 v[102:103], v4, s[12:15], s32 offen offset:96
    buffer_load_dwordx2 v[110:111], v4, s[16:19], s32 offen offset:96
    buffer_load_ushort v112, v7, s[20:23], 0 offen offset:0
    buffer_load_ushort v116, v8, s[48:51], 0 offen offset:0
    buffer_load_ushort v113, v7, s[20:23], 0 offen offset:8
    buffer_load_ushort v117, v8, s[48:51], 0 offen offset:8
    buffer_load_ushort v114, v7, s[20:23], 0 offen offset:16
    buffer_load_ushort v118, v8, s[48:51], 0 offen offset:16
    buffer_load_ushort v115, v7, s[20:23], 0 offen offset:24
    buffer_load_ushort v119, v8, s[48:51], 0 offen offset:24
    buffer_load_ushort v120, v9, s[60:63], 0 offen
    buffer_load_ushort v121, v9, s[64:67], 0 offen
    s_lshl_b32 s46, s2, 7
    s_lshl_b32 s45, s30, 5
    s_add_u32 s46, s46, s45
    s_add_u32 s46, s46, 16777216
    s_lshl_b32 s47, s2, 16
    s_lshl_b32 s45, s30, 11
    s_add_u32 s47, s47, s45
    s_waitcnt vmcnt(0)
    v_lshlrev_b32 v112, 16, v112
    v_lshlrev_b32 v113, 16, v113
    v_lshlrev_b32 v114, 16, v114
    v_lshlrev_b32 v115, 16, v115
    v_lshlrev_b32 v116, 16, v116
    v_lshlrev_b32 v117, 16, v117
    v_lshlrev_b32 v118, 16, v118
    v_lshlrev_b32 v119, 16, v119
    v_cmp_eq_u32 vcc, 0, v3
    v_mov_b32 v31, 0
    v_mov_b32 v30, 0
    v_cndmask_b32 v115, 0, v115, vcc
    v_fmac_f32 v31, v112, v116
    v_fmac_f32 v31, v113, v117
    v_fmac_f32 v31, v114, v118
    v_fmac_f32 v31, v115, v119
    v_xor_b32 v11, 16, v1
    v_lshlrev_b32 v11, 2, v11
    v_xor_b32 v9, 32, v1
    v_lshlrev_b32 v9, 2, v9
    ds_bpermute_b32 v28, v11, v31
    v_lshlrev_b32 v120, 16, v120
    v_lshlrev_b32 v121, 16, v121
    s_waitcnt lgkmcnt(0)
    v_add_f32 v31, v31, v28
    ds_bpermute_b32 v28, v9, v31
    v_lshlrev_b32 v64, 16, v96
    v_lshlrev_b32 v80, 16, v104
    v_and_b32 v65, 0xffff0000, v96
    v_and_b32 v81, 0xffff0000, v104
    v_lshlrev_b32 v66, 16, v97
    v_lshlrev_b32 v82, 16, v105
    v_and_b32 v67, 0xffff0000, v97
    v_and_b32 v83, 0xffff0000, v105
    v_lshlrev_b32 v68, 16, v98
    v_lshlrev_b32 v84, 16, v106
    v_and_b32 v69, 0xffff0000, v98
    v_and_b32 v85, 0xffff0000, v106
    v_lshlrev_b32 v70, 16, v99
    v_lshlrev_b32 v86, 16, v107
    v_and_b32 v71, 0xffff0000, v99
    v_and_b32 v87, 0xffff0000, v107
    v_lshlrev_b32 v72, 16, v100
    v_lshlrev_b32 v88, 16, v108
    v_and_b32 v73, 0xffff0000, v100
    v_and_b32 v89, 0xffff0000, v108
    v_lshlrev_b32 v74, 16, v101
    v_lshlrev_b32 v90, 16, v109
    v_and_b32 v75, 0xffff0000, v101
    v_and_b32 v91, 0xffff0000, v109
    v_lshlrev_b32 v76, 16, v102
    v_lshlrev_b32 v92, 16, v110
    v_and_b32 v77, 0xffff0000, v102
    v_and_b32 v93, 0xffff0000, v110
    v_lshlrev_b32 v78, 16, v103
    v_lshlrev_b32 v94, 16, v111
    v_and_b32 v79, 0xffff0000, v103
    v_and_b32 v95, 0xffff0000, v111
    s_waitcnt lgkmcnt(0)
    v_add_f32 v31, v31, v28
    v_cvt_pk_bf16_f32 v31, v31, v31
    v_lshlrev_b32 v31, 16, v31
    v_add_f32 v31, v31, v120
    v_cvt_pk_bf16_f32 v31, v31, v31
    v_lshlrev_b32 v31, 16, v31
    v_mov_b32 v12, 0
    v_mov_b32 v13, 0
    v_mov_b32 v14, 0
    v_mov_b32 v15, 0
    v_mov_b32 v16, 0
    v_mov_b32 v17, 0
    v_mov_b32 v18, 0
    v_mov_b32 v19, 0
    v_mov_b32 v20, 0
    v_mov_b32 v21, 0
    v_mov_b32 v22, 0
    v_mov_b32 v23, 0
    v_mov_b32 v24, 0
    v_mov_b32 v25, 0
    v_mov_b32 v26, 0
    v_mov_b32 v27, 0
    s_mov_b32 s37, 0
    s_sub_u32 s45, s31, 1
    s_and_b32 s45, s45, 7
    s_lshl_b32 s45, 1, s45
    s_or_b32 s37, s37, s45
    s_sub_u32 s45, s31, 2
    s_and_b32 s45, s45, 7
    s_lshl_b32 s45, 1, s45
    s_or_b32 s37, s37, s45
    s_sub_u32 s45, s31, 3
    s_and_b32 s45, s45, 7
    s_lshl_b32 s45, 1, s45
    s_or_b32 s37, s37, s45
L_pl_1:
    buffer_load_dword v29, v10, s[24:27], s46 offen sc1
    s_waitcnt vmcnt(0)
    v_cmp_eq_u32 vcc, 1, v29
    s_nop 3
    s_and_b32 s45, vcc_lo, s37
    s_cmp_eq_u32 s45, s37
    s_cbranch_scc0 L_pl_1
    s_sub_u32 s45, s31, 1
    s_and_b32 s45, s45, 7
    s_lshl_b32 s45, s45, 13
    s_add_u32 s45, s45, s47
    buffer_load_dwordx4 v[32:35], v2, s[24:27], s45 offen sc1
    buffer_load_dwordx4 v[36:39], v2, s[24:27], s45 offen offset:1024 sc1
    s_sub_u32 s45, s31, 2
    s_and_b32 s45, s45, 7
    s_lshl_b32 s45, s45, 13
    s_add_u32 s45, s45, s47
    buffer_load_dwordx4 v[40:43], v2, s[24:27], s45 offen sc1
    buffer_load_dwordx4 v[44:47], v2, s[24:27], s45 offen offset:1024 sc1
    s_sub_u32 s45, s31, 3
    s_and_b32 s45, s45, 7
    s_lshl_b32 s45, s45, 13
    s_add_u32 s45, s45, s47
    buffer_load_dwordx4 v[48:51], v2, s[24:27], s45 offen sc1
    buffer_load_dwordx4 v[52:55], v2, s[24:27], s45 offen offset:1024 sc1
    s_mov_b32 s37, 0
    s_sub_u32 s45, s31, 4
    s_and_b32 s45, s45, 7
    s_lshl_b32 s45, 1, s45
    s_or_b32 s37, s37, s45
    s_sub_u32 s45, s31, 5
    s_and_b32 s45, s45, 7
    s_lshl_b32 s45, 1, s45
    s_or_b32 s37, s37, s45
    s_sub_u32 s45, s31, 6
    s_and_b32 s45, s45, 7
    s_lshl_b32 s45, 1, s45
    s_or_b32 s37, s37, s45
L_pl_2:
    buffer_load_dword v29, v10, s[24:27], s46 offen sc1
    s_waitcnt vmcnt(0)
    v_cmp_eq_u32 vcc, 1, v29
    s_nop 3
    s_and_b32 s45, vcc_lo, s37
    s_cmp_eq_u32 s45, s37
    s_cbranch_scc0 L_pl_2
    v_lshlrev_b32 v7, 16, v32
    v_and_b32 v8, 0xffff0000, v32
    v_add_f32 v12, v12, v7
    v_add_f32 v13, v13, v8
    v_lshlrev_b32 v7, 16, v33
    v_and_b32 v8, 0xffff0000, v33
    v_add_f32 v14, v14, v7
    v_add_f32 v15, v15, v8
    v_lshlrev_b32 v7, 16, v34
    v_and_b32 v8, 0xffff0000, v34
    v_add_f32 v16, v16, v7
    v_add_f32 v17, v17, v8
    v_lshlrev_b32 v7, 16, v35
    v_and_b32 v8, 0xffff0000, v35
    v_add_f32 v18, v18, v7
    v_add_f32 v19, v19, v8
    v_lshlrev_b32 v7, 16, v36
    v_and_b32 v8, 0xffff0000, v36
    v_add_f32 v20, v20, v7
    v_add_f32 v21, v21, v8
    v_lshlrev_b32 v7, 16, v37
    v_and_b32 v8, 0xffff0000, v37
    v_add_f32 v22, v22, v7
    v_add_f32 v23, v23, v8
    v_lshlrev_b32 v7, 16, v38
    v_and_b32 v8, 0xffff0000, v38
    v_add_f32 v24, v24, v7
    v_add_f32 v25, v25, v8
    v_lshlrev_b32 v7, 16, v39
    v_and_b32 v8, 0xffff0000, v39
    v_add_f32 v26, v26, v7
    v_add_f32 v27, v27, v8
    v_lshlrev_b32 v7, 16, v40
    v_and_b32 v8, 0xffff0000, v40
    v_add_f32 v12, v12, v7
    v_add_f32 v13, v13, v8
    v_lshlrev_b32 v7, 16, v41
    v_and_b32 v8, 0xffff0000, v41
    v_add_f32 v14, v14, v7
    v_add_f32 v15, v15, v8
    v_lshlrev_b32 v7, 16, v42
    v_and_b32 v8, 0xffff0000, v42
    v_add_f32 v16, v16, v7
    v_add_f32 v17, v17, v8
    v_lshlrev_b32 v7, 16, v43
    v_and_b32 v8, 0xffff0000, v43
    v_add_f32 v18, v18, v7
    v_add_f32 v19, v19, v8
    v_lshlrev_b32 v7, 16, v44
    v_and_b32 v8, 0xffff0000, v44
    v_add_f32 v20, v20, v7
    v_add_f32 v21, v21, v8
    v_lshlrev_b32 v7, 16, v45
    v_and_b32 v8, 0xffff0000, v45
    v_add_f32 v22, v22, v7
    v_add_f32 v23, v23, v8
    v_lshlrev_b32 v7, 16, v46
    v_and_b32 v8, 0xffff0000, v46
    v_add_f32 v24, v24, v7
    v_add_f32 v25, v25, v8
    v_lshlrev_b32 v7, 16, v47
    v_and_b32 v8, 0xffff0000, v47
    v_add_f32 v26, v26, v7
    v_add_f32 v27, v27, v8
    v_lshlrev_b32 v7, 16, v48
    v_and_b32 v8, 0xffff0000, v48
    v_add_f32 v12, v12, v7
    v_add_f32 v13, v13, v8
    v_lshlrev_b32 v7, 16, v49
    v_and_b32 v8, 0xffff0000, v49
    v_add_f32 v14, v14, v7
    v_add_f32 v15, v15, v8
    v_lshlrev_b32 v7, 16, v50
    v_and_b32 v8, 0xffff0000, v50
    v_add_f32 v16, v16, v7
    v_add_f32 v17, v17, v8
    v_lshlrev_b32 v7, 16, v51
    v_and_b32 v8, 0xffff0000, v51
    v_add_f32 v18, v18, v7
    v_add_f32 v19, v19, v8
    v_lshlrev_b32 v7, 16, v52
    v_and_b32 v8, 0xffff0000, v52
    v_add_f32 v20, v20, v7
    v_add_f32 v21, v21, v8
    v_lshlrev_b32 v7, 16, v53
    v_and_b32 v8, 0xffff0000, v53
    v_add_f32 v22, v22, v7
    v_add_f32 v23, v23, v8
    v_lshlrev_b32 v7, 16, v54
    v_and_b32 v8, 0xffff0000, v54
    v_add_f32 v24, v24, v7
    v_add_f32 v25, v25, v8
    v_lshlrev_b32 v7, 16, v55
    v_and_b32 v8, 0xffff0000, v55
    v_add_f32 v26, v26, v7
    v_add_f32 v27, v27, v8
    s_sub_u32 s45, s31, 4
    s_and_b32 s45, s45, 7
    s_lshl_b32 s45, s45, 13
    s_add_u32 s45, s45, s47
    buffer_load_dwordx4 v[32:35], v2, s[24:27], s45 offen sc1
    buffer_load_dwordx4 v[36:39], v2, s[24:27], s45 offen offset:1024 sc1
    s_sub_u32 s45, s31, 5
    s_and_b32 s45, s45, 7
    s_lshl_b32 s45, s45, 13
    s_add_u32 s45, s45, s47
    buffer_load_dwordx4 v[40:43], v2, s[24:27], s45 offen sc1
    buffer_load_dwordx4 v[44:47], v2, s[24:27], s45 offen offset:1024 sc1
    s_sub_u32 s45, s31, 6
    s_and_b32 s45, s45, 7
    s_lshl_b32 s45, s45, 13
    s_add_u32 s45, s45, s47
    buffer_load_dwordx4 v[48:51], v2, s[24:27], s45 offen sc1
    buffer_load_dwordx4 v[52:55], v2, s[24:27], s45 offen offset:1024 sc1
    s_mov_b32 s37, 0
    s_sub_u32 s45, s31, 7
    s_and_b32 s45, s45, 7
    s_lshl_b32 s45, 1, s45
    s_or_b32 s37, s37, s45
L_pl_3:
    buffer_load_dword v29, v10, s[24:27], s46 offen sc1
    s_waitcnt vmcnt(0)
    v_cmp_eq_u32 vcc, 1, v29
    s_nop 3
    s_and_b32 s45, vcc_lo, s37
    s_cmp_eq_u32 s45, s37
    s_cbranch_scc0 L_pl_3
    s_sub_u32 s45, s31, 7
    s_and_b32 s45, s45, 7
    s_lshl_b32 s45, s45, 13
    s_add_u32 s45, s45, s47
    buffer_load_dwordx4 v[56:59], v2, s[24:27], s45 offen sc1
    buffer_load_dwordx4 v[60:63], v2, s[24:27], s45 offen offset:1024 sc1
    s_barrier
    s_lshl_b32 s45, s30, 13
    s_add_u32 s45, s45, 65536
    v_add_u32 v28, s45, v2
    ds_read_b128 v[96:99], v28 offset:0
    ds_read_b128 v[100:103], v28 offset:1024
    ds_read_b128 v[104:107], v28 offset:2048
    ds_read_b128 v[108:111], v28 offset:3072
    v_lshlrev_b32 v7, 16, v32
    v_and_b32 v8, 0xffff0000, v32
    v_add_f32 v12, v12, v7
    v_add_f32 v13, v13, v8
    v_lshlrev_b32 v7, 16, v33
    v_and_b32 v8, 0xffff0000, v33
    v_add_f32 v14, v14, v7
    v_add_f32 v15, v15, v8
    v_lshlrev_b32 v7, 16, v34
    v_and_b32 v8, 0xffff0000, v34
    v_add_f32 v16, v16, v7
    v_add_f32 v17, v17, v8
    v_lshlrev_b32 v7, 16, v35
    v_and_b32 v8, 0xffff0000, v35
    v_add_f32 v18, v18, v7
    v_add_f32 v19, v19, v8
    v_lshlrev_b32 v7, 16, v36
    v_and_b32 v8, 0xffff0000, v36
    v_add_f32 v20, v20, v7
    v_add_f32 v21, v21, v8
    v_lshlrev_b32 v7, 16, v37
    v_and_b32 v8, 0xffff0000, v37
    v_add_f32 v22, v22, v7
    v_add_f32 v23, v23, v8
    v_lshlrev_b32 v7, 16, v38
    v_and_b32 v8, 0xffff0000, v38
    v_add_f32 v24, v24, v7
    v_add_f32 v25, v25, v8
    v_lshlrev_b32 v7, 16, v39
    v_and_b32 v8, 0xffff0000, v39
    v_add_f32 v26, v26, v7
    v_add_f32 v27, v27, v8
    v_lshlrev_b32 v7, 16, v40
    v_and_b32 v8, 0xffff0000, v40
    v_add_f32 v12, v12, v7
    v_add_f32 v13, v13, v8
    v_lshlrev_b32 v7, 16, v41
    v_and_b32 v8, 0xffff0000, v41
    v_add_f32 v14, v14, v7
    v_add_f32 v15, v15, v8
    v_lshlrev_b32 v7, 16, v42
    v_and_b32 v8, 0xffff0000, v42
    v_add_f32 v16, v16, v7
    v_add_f32 v17, v17, v8
    v_lshlrev_b32 v7, 16, v43
    v_and_b32 v8, 0xffff0000, v43
    v_add_f32 v18, v18, v7
    v_add_f32 v19, v19, v8
    v_lshlrev_b32 v7, 16, v44
    v_and_b32 v8, 0xffff0000, v44
    v_add_f32 v20, v20, v7
    v_add_f32 v21, v21, v8
    v_lshlrev_b32 v7, 16, v45
    v_and_b32 v8, 0xffff0000, v45
    v_add_f32 v22, v22, v7
    v_add_f32 v23, v23, v8
    v_lshlrev_b32 v7, 16, v46
    v_and_b32 v8, 0xffff0000, v46
    v_add_f32 v24, v24, v7
    v_add_f32 v25, v25, v8
    v_lshlrev_b32 v7, 16, v47
    v_and_b32 v8, 0xffff0000, v47
    v_add_f32 v26, v26, v7
    v_add_f32 v27, v27, v8
    v_lshlrev_b32 v7, 16, v48
    v_and_b32 v8, 0xffff0000, v48
    v_add_f32 v12, v12, v7
    v_add_f32 v13, v13, v8
    v_lshlrev_b32 v7, 16, v49
    v_and_b32 v8, 0xffff0000, v49
    v_add_f32 v14, v14, v7
    v_add_f32 v15, v15, v8
    v_lshlrev_b32 v7, 16, v50
    v_and_b32 v8, 0xffff0000, v50
    v_add_f32 v16, v16, v7
    v_add_f32 v17, v17, v8
    v_lshlrev_b32 v7, 16, v51
    v_and_b32 v8, 0xffff0000, v51
    v_add_f32 v18, v18, v7
    v_add_f32 v19, v19, v8
    v_lshlrev_b32 v7, 16, v52
    v_and_b32 v8, 0xffff0000, v52
    v_add_f32 v20, v20, v7
    v_add_f32 v21, v21, v8
    v_lshlrev_b32 v7, 16, v53
    v_and_b32 v8, 0xffff0000, v53
    v_add_f32 v22, v22, v7
    v_add_f32 v23, v23, v8
    v_lshlrev_b32 v7, 16, v54
    v_and_b32 v8, 0xffff0000, v54
    v_add_f32 v24, v24, v7
    v_add_f32 v25, v25, v8
    v_lshlrev_b32 v7, 16, v55
    v_and_b32 v8, 0xffff0000, v55
    v_add_f32 v26, v26, v7
    v_add_f32 v27, v27, v8
    s_waitcnt lgkmcnt(0)
    v_add_f32 v12, v12, v96
    v_add_f32 v13, v13, v97
    v_add_f32 v14, v14, v98
    v_add_f32 v15, v15, v99
    v_add_f32 v16, v16, v100
    v_add_f32 v17, v17, v101
    v_add_f32 v18, v18, v102
    v_add_f32 v19, v19, v103
    v_add_f32 v20, v20, v104
    v_add_f32 v21, v21, v105
    v_add_f32 v22, v22, v106
    v_add_f32 v23, v23, v107
    v_add_f32 v24, v24, v108
    v_add_f32 v25, v25, v109
    v_add_f32 v26, v26, v110
    v_add_f32 v27, v27, v111
    s_waitcnt vmcnt(0)
    v_lshlrev_b32 v7, 16, v56
    v_and_b32 v8, 0xffff0000, v56
    v_add_f32 v12, v12, v7
    v_add_f32 v13, v13, v8
    v_lshlrev_b32 v7, 16, v57
    v_and_b32 v8, 0xffff0000, v57
    v_add_f32 v14, v14, v7
    v_add_f32 v15, v15, v8
    v_lshlrev_b32 v7, 16, v58
    v_and_b32 v8, 0xffff0000, v58
    v_add_f32 v16, v16, v7
    v_add_f32 v17, v17, v8
    v_lshlrev_b32 v7, 16, v59
    v_and_b32 v8, 0xffff0000, v59
    v_add_f32 v18, v18, v7
    v_add_f32 v19, v19, v8
    v_lshlrev_b32 v7, 16, v60
    v_and_b32 v8, 0xffff0000, v60
    v_add_f32 v20, v20, v7
    v_add_f32 v21, v21, v8
    v_lshlrev_b32 v7, 16, v61
    v_and_b32 v8, 0xffff0000, v61
    v_add_f32 v22, v22, v7
    v_add_f32 v23, v23, v8
    v_lshlrev_b32 v7, 16, v62
    v_and_b32 v8, 0xffff0000, v62
    v_add_f32 v24, v24, v7
    v_add_f32 v25, v25, v8
    v_lshlrev_b32 v7, 16, v63
    v_and_b32 v8, 0xffff0000, v63
    v_add_f32 v26, v26, v7
    v_add_f32 v27, v27, v8
    v_cvt_pk_bf16_f32 v32, v12, v13
    v_cvt_pk_bf16_f32 v33, v14, v15
    v_cvt_pk_bf16_f32 v34, v16, v17
    v_cvt_pk_bf16_f32 v35, v18, v19
    v_cvt_pk_bf16_f32 v36, v20, v21
    v_cvt_pk_bf16_f32 v37, v22, v23
    v_cvt_pk_bf16_f32 v38, v24, v25
    v_cvt_pk_bf16_f32 v39, v26, v27
    v_lshlrev_b32 v12, 16, v32
    v_and_b32 v13, 0xffff0000, v32
    v_add_f32 v12, v12, v64
    v_add_f32 v13, v13, v65
    v_cvt_pk_bf16_f32 v32, v12, v13
    v_lshlrev_b32 v14, 16, v33
    v_and_b32 v15, 0xffff0000, v33
    v_add_f32 v14, v14, v66
    v_add_f32 v15, v15, v67
    v_cvt_pk_bf16_f32 v33, v14, v15
    v_lshlrev_b32 v16, 16, v34
    v_and_b32 v17, 0xffff0000, v34
    v_add_f32 v16, v16, v68
    v_add_f32 v17, v17, v69
    v_cvt_pk_bf16_f32 v34, v16, v17
    v_lshlrev_b32 v18, 16, v35
    v_and_b32 v19, 0xffff0000, v35
    v_add_f32 v18, v18, v70
    v_add_f32 v19, v19, v71
    v_cvt_pk_bf16_f32 v35, v18, v19
    v_lshlrev_b32 v20, 16, v36
    v_and_b32 v21, 0xffff0000, v36
    v_add_f32 v20, v20, v72
    v_add_f32 v21, v21, v73
    v_cvt_pk_bf16_f32 v36, v20, v21
    v_lshlrev_b32 v22, 16, v37
    v_and_b32 v23, 0xffff0000, v37
    v_add_f32 v22, v22, v74
    v_add_f32 v23, v23, v75
    v_cvt_pk_bf16_f32 v37, v22, v23
    v_lshlrev_b32 v24, 16, v38
    v_and_b32 v25, 0xffff0000, v38
    v_add_f32 v24, v24, v76
    v_add_f32 v25, v25, v77
    v_cvt_pk_bf16_f32 v38, v24, v25
    v_lshlrev_b32 v26, 16, v39
    v_and_b32 v27, 0xffff0000, v39
    v_add_f32 v26, v26, v78
    v_add_f32 v27, v27, v79
    v_cvt_pk_bf16_f32 v39, v26, v27
    v_lshlrev_b32 v12, 16, v32
    v_and_b32 v13, 0xffff0000, v32
    v_cmp_lt_f32 vcc, 0, v12
    v_cmp_lt_f32 s[36:37], 0, v13
    v_mul_f32 v12, v12, v80
    v_mul_f32 v13, v13, v81
    v_cndmask_b32 v7, 0, 1.0, vcc
    v_cndmask_b32 v8, 0, 1.0, s[36:37]
    v_fmac_f32 v30, v12, v7
    v_fmac_f32 v30, v13, v8
    v_lshlrev_b32 v14, 16, v33
    v_and_b32 v15, 0xffff0000, v33
    v_cmp_lt_f32 vcc, 0, v14
    v_cmp_lt_f32 s[36:37], 0, v15
    v_mul_f32 v14, v14, v82
    v_mul_f32 v15, v15, v83
    v_cndmask_b32 v7, 0, 1.0, vcc
    v_cndmask_b32 v8, 0, 1.0, s[36:37]
    v_fmac_f32 v30, v14, v7
    v_fmac_f32 v30, v15, v8
    v_lshlrev_b32 v16, 16, v34
    v_and_b32 v17, 0xffff0000, v34
    v_cmp_lt_f32 vcc, 0, v16
    v_cmp_lt_f32 s[36:37], 0, v17
    v_mul_f32 v16, v16, v84
    v_mul_f32 v17, v17, v85
    v_cndmask_b32 v7, 0, 1.0, vcc
    v_cndmask_b32 v8, 0, 1.0, s[36:37]
    v_fmac_f32 v30, v16, v7
    v_fmac_f32 v30, v17, v8
    v_lshlrev_b32 v18, 16, v35
    v_and_b32 v19, 0xffff0000, v35
    v_cmp_lt_f32 vcc, 0, v18
    v_cmp_lt_f32 s[36:37], 0, v19
    v_mul_f32 v18, v18, v86
    v_mul_f32 v19, v19, v87
    v_cndmask_b32 v7, 0, 1.0, vcc
    v_cndmask_b32 v8, 0, 1.0, s[36:37]
    v_fmac_f32 v30, v18, v7
    v_fmac_f32 v30, v19, v8
    v_lshlrev_b32 v20, 16, v36
    v_and_b32 v21, 0xffff0000, v36
    v_cmp_lt_f32 vcc, 0, v20
    v_cmp_lt_f32 s[36:37], 0, v21
    v_mul_f32 v20, v20, v88
    v_mul_f32 v21, v21, v89
    v_cndmask_b32 v7, 0, 1.0, vcc
    v_cndmask_b32 v8, 0, 1.0, s[36:37]
    v_fmac_f32 v30, v20, v7
    v_fmac_f32 v30, v21, v8
    v_lshlrev_b32 v22, 16, v37
    v_and_b32 v23, 0xffff0000, v37
    v_cmp_lt_f32 vcc, 0, v22
    v_cmp_lt_f32 s[36:37], 0, v23
    v_mul_f32 v22, v22, v90
    v_mul_f32 v23, v23, v91
    v_cndmask_b32 v7, 0, 1.0, vcc
    v_cndmask_b32 v8, 0, 1.0, s[36:37]
    v_fmac_f32 v30, v22, v7
    v_fmac_f32 v30, v23, v8
    v_lshlrev_b32 v24, 16, v38
    v_and_b32 v25, 0xffff0000, v38
    v_cmp_lt_f32 vcc, 0, v24
    v_cmp_lt_f32 s[36:37], 0, v25
    v_mul_f32 v24, v24, v92
    v_mul_f32 v25, v25, v93
    v_cndmask_b32 v7, 0, 1.0, vcc
    v_cndmask_b32 v8, 0, 1.0, s[36:37]
    v_fmac_f32 v30, v24, v7
    v_fmac_f32 v30, v25, v8
    v_lshlrev_b32 v26, 16, v39
    v_and_b32 v27, 0xffff0000, v39
    v_cmp_lt_f32 vcc, 0, v26
    v_cmp_lt_f32 s[36:37], 0, v27
    v_mul_f32 v26, v26, v94
    v_mul_f32 v27, v27, v95
    v_cndmask_b32 v7, 0, 1.0, vcc
    v_cndmask_b32 v8, 0, 1.0, s[36:37]
    v_fmac_f32 v30, v26, v7
    v_fmac_f32 v30, v27, v8
    ds_bpermute_b32 v7, v11, v30
    s_lshl_b32 s32, s30, 6
    s_add_u32 s32, s32, 98304
    v_lshlrev_b32 v10, 2, v5
    s_waitcnt lgkmcnt(0)
    v_add_f32 v30, v30, v7
    ds_bpermute_b32 v7, v9, v30
    v_add_u32 v11, s32, v10
    v_add_u32 v10, 98304, v10
    s_waitcnt lgkmcnt(0)
    v_add_f32 v30, v30, v7
    ds_write_b32 v11, v30
    s_waitcnt lgkmcnt(0)
    s_barrier
    s_cmp_lg_u32 s30, 0
    s_cbranch_scc1 L_end
    ds_read_b32 v32, v10 offset:0
    ds_read_b32 v33, v10 offset:64
    ds_read_b32 v34, v10 offset:128
    ds_read_b32 v35, v10 offset:192
    v_lshlrev_b32 v6, 1, v6
    s_waitcnt lgkmcnt(0)
    v_add_f32 v32, v32, v33
    v_add_f32 v34, v34, v35
    v_add_f32 v32, v32, v34
    v_cvt_pk_bf16_f32 v32, v32, v32
    v_lshlrev_b32 v32, 16, v32
    v_add_f32 v32, v32, v121
    v_cvt_pk_bf16_f32 v32, v32, v32
    v_lshlrev_b32 v32, 16, v32
    v_add_f32 v32, v31, v32
    v_cvt_pk_bf16_f32 v32, v32, v32
    v_lshlrev_b32 v32, 16, v32
    v_mul_f32 v32, 0xbfb8aa3b, v32
    v_exp_f32 v32, v32
    s_nop 0
    v_add_f32 v32, 1.0, v32
    v_rcp_f32 v32, v32
    s_nop 0
    v_cvt_pk_bf16_f32 v32, v32, v32
    s_mov_b64 exec, 0xffff
    buffer_store_short v32, v6, s[76:79], 0 offen
    s_mov_b64 exec, -1
    s_endpgm
L_mfma:
    v_lshrrev_b32 v25, 4, v1
    v_and_b32 v24, 15, v1
    v_bfe_u32 v26, v1, 1, 3
    v_xor_b32 v26, v25, v26
    v_lshlrev_b32 v26, 4, v26
    v_lshl_add_u32 v6, v24, 7, v26
    v_xor_b32 v7, 64, v6
    s_lshl_b32 s45, s35, 6
    v_xor_b32 v8, s45, v6
    s_lshl_b32 s42, s30, 13
    s_add_u32 s42, s42, 65536
    v_bfe_u32 v26, v1, 2, 2
    v_lshlrev_b32 v27, 7, v26
    v_lshl_add_u32 v27, v25, 10, v27
    v_and_b32 v28, 3, v1
    v_lshl_add_u32 v27, v28, 3, v27
    v_add_u32 v27, s42, v27
    v_lshrrev_b32 v26, 1, v26
    v_and_b32 v28, 1, v25
    v_lshl_add_u32 v26, v28, 1, v26
    v_xor_b32 v28, 0, v26
    v_lshl_add_u32 v2, v28, 5, v27
    v_xor_b32 v28, 1, v26
    v_lshl_add_u32 v3, v28, 5, v27
    v_xor_b32 v28, 2, v26
    v_lshl_add_u32 v4, v28, 5, v27
    v_xor_b32 v28, 3, v26
    v_lshl_add_u32 v5, v28, 5, v27
    v_lshlrev_b32 v9, 4, v1
    v_mov_b32 v10, 0
    v_mov_b32 v11, 1
    s_waitcnt lgkmcnt(0)
    s_mov_b32 s24, s58
    s_and_b32 s25, s59, 0xffff
    s_mov_b32 s26, 268435456
    s_mov_b32 s27, 0x00020000
    s_mov_b32 s60, s56
    s_and_b32 s61, s57, 0xffff
    s_mov_b32 s62, 256
    s_mov_b32 s63, 0x00020000
    s_lshl_b32 s46, s32, 3
    s_cmp_lg_u32 s30, 0
    s_cbranch_scc1 L_pf
    s_lshl_b32 s45, s2, 7
    s_add_u32 s45, s45, 16777216
    v_lshlrev_b32 v24, 2, v1
    s_mov_b64 exec, 0xffffffff
    buffer_store_dword v10, v24, s[24:27], s45 offen sc1
    s_waitcnt vmcnt(0)
    s_mov_b64 exec, 1
    buffer_atomic_add v11, v10, s[60:63], s46 offen
    s_mov_b64 exec, -1
    s_branch L_pfd
L_pf:
    s_sub_u32 s45, s30, 1
    s_lshl_b32 s45, s45, 13
    v_lshlrev_b32 v24, 7, v1
    v_add_u32 v24, s45, v24
    v_min_u32 v24, L_end-L_pc, v24
    global_load_dword v0, v24, s[28:29]
L_pfd:
    s_lshl_b32 s64, s32, 19
    s_lshl_b32 s45, s31, 13
    s_add_u32 s64, s64, s45
    s_lshl_b32 s45, s30, 11
    s_add_u32 s64, s64, s45
    s_lshl_b32 s65, s32, 10
    s_lshl_b32 s45, s30, 5
    s_add_u32 s65, s65, s45
    s_add_u32 s65, s65, 16777216
    s_lshl_b32 s45, s31, 2
    s_add_u32 s65, s65, s45
    s_mov_b32 s49, 0
    s_barrier
    ds_read_b64_tr_b16 v[48:49], v2 offset:0
    ds_read_b64_tr_b16 v[50:51], v2 offset:512
    ds_read_b64_tr_b16 v[52:53], v3 offset:0
    ds_read_b64_tr_b16 v[54:55], v3 offset:512
    ds_read_b64_tr_b16 v[56:57], v4 offset:0
    ds_read_b64_tr_b16 v[58:59], v4 offset:512
    ds_read_b64_tr_b16 v[60:61], v5 offset:0
    ds_read_b64_tr_b16 v[62:63], v5 offset:512
    ds_read_b64_tr_b16 v[64:65], v2 offset:4096
    ds_read_b64_tr_b16 v[66:67], v2 offset:4608
    ds_read_b64_tr_b16 v[68:69], v3 offset:4096
    ds_read_b64_tr_b16 v[70:71], v3 offset:4608
    ds_read_b64_tr_b16 v[72:73], v4 offset:4096
    ds_read_b64_tr_b16 v[74:75], v4 offset:4608
    ds_read_b64_tr_b16 v[76:77], v5 offset:4096
    ds_read_b64_tr_b16 v[78:79], v5 offset:4608
    s_waitcnt lgkmcnt(0)
    s_barrier
    ds_read_b128 v[24:27], v6 offset:0
    ds_read_b128 v[28:31], v6 offset:2048
    ds_read_b128 v[32:35], v6 offset:4096
    ds_read_b128 v[36:39], v6 offset:6144
    ds_read_b128 v[40:43], v6 offset:8192
    ds_read_b128 v[44:47], v6 offset:10240
    s_waitcnt lgkmcnt(5)
    v_mfma_f32_16x16x32_bf16 a[0:3], v[48:51], v[24:27], 0
    v_mfma_f32_16x16x32_bf16 a[4:7], v[52:55], v[24:27], 0
    v_mfma_f32_16x16x32_bf16 a[8:11], v[56:59], v[24:27], 0
    v_mfma_f32_16x16x32_bf16 a[12:15], v[60:63], v[24:27], 0
    ds_read_b128 v[24:27], v6 offset:12288
    s_waitcnt lgkmcnt(5)
    v_mfma_f32_16x16x32_bf16 a[16:19], v[48:51], v[28:31], 0
    v_mfma_f32_16x16x32_bf16 a[20:23], v[52:55], v[28:31], 0
    ds_read_b64_tr_b16 v[80:81], v2 offset:32768
    v_mfma_f32_16x16x32_bf16 a[24:27], v[56:59], v[28:31], 0
    v_mfma_f32_16x16x32_bf16 a[28:31], v[60:63], v[28:31], 0
    ds_read_b128 v[28:31], v6 offset:14336
    s_waitcnt lgkmcnt(6)
    v_mfma_f32_16x16x32_bf16 a[32:35], v[48:51], v[32:35], 0
    ds_read_b64_tr_b16 v[82:83], v2 offset:33280
    v_mfma_f32_16x16x32_bf16 a[36:39], v[52:55], v[32:35], 0
    ds_read_b64_tr_b16 v[84:85], v3 offset:32768
    v_mfma_f32_16x16x32_bf16 a[40:43], v[56:59], v[32:35], 0
    v_mfma_f32_16x16x32_bf16 a[44:47], v[60:63], v[32:35], 0
    ds_read_b128 v[32:35], v7 offset:0
    s_waitcnt lgkmcnt(8)
    v_mfma_f32_16x16x32_bf16 a[48:51], v[48:51], v[36:39], 0
    ds_read_b64_tr_b16 v[86:87], v3 offset:33280
    v_mfma_f32_16x16x32_bf16 a[52:55], v[52:55], v[36:39], 0
    v_mfma_f32_16x16x32_bf16 a[56:59], v[56:59], v[36:39], 0
    v_mfma_f32_16x16x32_bf16 a[60:63], v[60:63], v[36:39], 0
    ds_read_b128 v[36:39], v7 offset:2048
    s_waitcnt lgkmcnt(9)
    v_mfma_f32_16x16x32_bf16 a[64:67], v[48:51], v[40:43], 0
    ds_read_b64_tr_b16 v[88:89], v4 offset:32768
    v_mfma_f32_16x16x32_bf16 a[68:71], v[52:55], v[40:43], 0
    ds_read_b64_tr_b16 v[90:91], v4 offset:33280
    v_mfma_f32_16x16x32_bf16 a[72:75], v[56:59], v[40:43], 0
    v_mfma_f32_16x16x32_bf16 a[76:79], v[60:63], v[40:43], 0
    ds_read_b128 v[40:43], v7 offset:4096
    s_waitcnt lgkmcnt(11)
    v_mfma_f32_16x16x32_bf16 a[80:83], v[48:51], v[44:47], 0
    ds_read_b64_tr_b16 v[92:93], v5 offset:32768
    v_mfma_f32_16x16x32_bf16 a[84:87], v[52:55], v[44:47], 0
    ds_read_b64_tr_b16 v[94:95], v5 offset:33280
    v_mfma_f32_16x16x32_bf16 a[88:91], v[56:59], v[44:47], 0
    v_mfma_f32_16x16x32_bf16 a[92:95], v[60:63], v[44:47], 0
    ds_read_b128 v[44:47], v7 offset:6144
    s_waitcnt lgkmcnt(13)
    v_mfma_f32_16x16x32_bf16 a[96:99], v[48:51], v[24:27], 0
    v_mfma_f32_16x16x32_bf16 a[100:103], v[52:55], v[24:27], 0
    v_mfma_f32_16x16x32_bf16 a[104:107], v[56:59], v[24:27], 0
    v_mfma_f32_16x16x32_bf16 a[108:111], v[60:63], v[24:27], 0
    ds_read_b128 v[24:27], v7 offset:8192
    s_waitcnt lgkmcnt(12)
    v_mfma_f32_16x16x32_bf16 a[112:115], v[48:51], v[28:31], 0
    ds_read_b64_tr_b16 v[96:97], v2 offset:36864
    v_mfma_f32_16x16x32_bf16 a[116:119], v[52:55], v[28:31], 0
    ds_read_b64_tr_b16 v[98:99], v2 offset:37376
    v_mfma_f32_16x16x32_bf16 a[120:123], v[56:59], v[28:31], 0
    v_mfma_f32_16x16x32_bf16 a[124:127], v[60:63], v[28:31], 0
    ds_read_b128 v[28:31], v7 offset:10240
    s_waitcnt lgkmcnt(12)
    v_mfma_f32_16x16x32_bf16 a[0:3], v[64:67], v[32:35], a[0:3]
    ds_read_b64_tr_b16 v[100:101], v3 offset:36864
    v_mfma_f32_16x16x32_bf16 a[4:7], v[68:71], v[32:35], a[4:7]
    ds_read_b64_tr_b16 v[102:103], v3 offset:37376
    v_mfma_f32_16x16x32_bf16 a[8:11], v[72:75], v[32:35], a[8:11]
    v_mfma_f32_16x16x32_bf16 a[12:15], v[76:79], v[32:35], a[12:15]
    ds_read_b128 v[32:35], v7 offset:12288
    s_waitcnt lgkmcnt(13)
    v_mfma_f32_16x16x32_bf16 a[16:19], v[64:67], v[36:39], a[16:19]
    ds_read_b64_tr_b16 v[104:105], v4 offset:36864
    v_mfma_f32_16x16x32_bf16 a[20:23], v[68:71], v[36:39], a[20:23]
    v_mfma_f32_16x16x32_bf16 a[24:27], v[72:75], v[36:39], a[24:27]
    v_mfma_f32_16x16x32_bf16 a[28:31], v[76:79], v[36:39], a[28:31]
    ds_read_b128 v[36:39], v7 offset:14336
    s_waitcnt lgkmcnt(12)
    v_mfma_f32_16x16x32_bf16 a[32:35], v[64:67], v[40:43], a[32:35]
    ds_read_b64_tr_b16 v[106:107], v4 offset:37376
    v_mfma_f32_16x16x32_bf16 a[36:39], v[68:71], v[40:43], a[36:39]
    ds_read_b64_tr_b16 v[108:109], v5 offset:36864
    v_mfma_f32_16x16x32_bf16 a[40:43], v[72:75], v[40:43], a[40:43]
    v_mfma_f32_16x16x32_bf16 a[44:47], v[76:79], v[40:43], a[44:47]
    s_waitcnt lgkmcnt(0)
    s_barrier
    ds_read_b128 v[40:43], v6 offset:16384
    v_mfma_f32_16x16x32_bf16 a[48:51], v[64:67], v[44:47], a[48:51]
    ds_read_b64_tr_b16 v[110:111], v5 offset:37376
    v_mfma_f32_16x16x32_bf16 a[52:55], v[68:71], v[44:47], a[52:55]
    v_mfma_f32_16x16x32_bf16 a[56:59], v[72:75], v[44:47], a[56:59]
    v_mfma_f32_16x16x32_bf16 a[60:63], v[76:79], v[44:47], a[60:63]
    ds_read_b128 v[44:47], v6 offset:18432
    v_mfma_f32_16x16x32_bf16 a[64:67], v[64:67], v[24:27], a[64:67]
    v_add_u32 v2, 32768, v2
    v_add_u32 v3, 32768, v3
    v_add_u32 v4, 32768, v4
    v_add_u32 v5, 32768, v5
    v_mfma_f32_16x16x32_bf16 a[68:71], v[68:71], v[24:27], a[68:71]
    ds_read_b64_tr_b16 v[112:113], v2 offset:32768
    v_mfma_f32_16x16x32_bf16 a[72:75], v[72:75], v[24:27], a[72:75]
    v_mfma_f32_16x16x32_bf16 a[76:79], v[76:79], v[24:27], a[76:79]
    ds_read_b128 v[24:27], v6 offset:20480
    v_mfma_f32_16x16x32_bf16 a[80:83], v[64:67], v[28:31], a[80:83]
    ds_read_b64_tr_b16 v[114:115], v2 offset:33280
    v_mfma_f32_16x16x32_bf16 a[84:87], v[68:71], v[28:31], a[84:87]
    ds_read_b64_tr_b16 v[116:117], v3 offset:32768
    v_mfma_f32_16x16x32_bf16 a[88:91], v[72:75], v[28:31], a[88:91]
    v_mfma_f32_16x16x32_bf16 a[92:95], v[76:79], v[28:31], a[92:95]
    ds_read_b128 v[28:31], v6 offset:22528
    v_mfma_f32_16x16x32_bf16 a[96:99], v[64:67], v[32:35], a[96:99]
    ds_read_b64_tr_b16 v[118:119], v3 offset:33280
    v_mfma_f32_16x16x32_bf16 a[100:103], v[68:71], v[32:35], a[100:103]
    v_mfma_f32_16x16x32_bf16 a[104:107], v[72:75], v[32:35], a[104:107]
    v_mfma_f32_16x16x32_bf16 a[108:111], v[76:79], v[32:35], a[108:111]
    ds_read_b128 v[32:35], v6 offset:24576
    v_mfma_f32_16x16x32_bf16 a[112:115], v[64:67], v[36:39], a[112:115]
    ds_read_b64_tr_b16 v[120:121], v4 offset:32768
    v_mfma_f32_16x16x32_bf16 a[116:119], v[68:71], v[36:39], a[116:119]
    ds_read_b64_tr_b16 v[122:123], v4 offset:33280
    v_mfma_f32_16x16x32_bf16 a[120:123], v[72:75], v[36:39], a[120:123]
    v_mfma_f32_16x16x32_bf16 a[124:127], v[76:79], v[36:39], a[124:127]
    ds_read_b128 v[36:39], v6 offset:26624
    s_waitcnt lgkmcnt(12)
    v_mfma_f32_16x16x32_bf16 a[0:3], v[80:83], v[40:43], a[0:3]
    ds_read_b64_tr_b16 v[124:125], v5 offset:32768
    v_mfma_f32_16x16x32_bf16 a[4:7], v[84:87], v[40:43], a[4:7]
    ds_read_b64_tr_b16 v[126:127], v5 offset:33280
    v_mfma_f32_16x16x32_bf16 a[8:11], v[88:91], v[40:43], a[8:11]
    v_mfma_f32_16x16x32_bf16 a[12:15], v[92:95], v[40:43], a[12:15]
    ds_read_b128 v[40:43], v6 offset:28672
    s_waitcnt lgkmcnt(13)
    v_mfma_f32_16x16x32_bf16 a[16:19], v[80:83], v[44:47], a[16:19]
    v_mfma_f32_16x16x32_bf16 a[20:23], v[84:87], v[44:47], a[20:23]
    v_mfma_f32_16x16x32_bf16 a[24:27], v[88:91], v[44:47], a[24:27]
    v_mfma_f32_16x16x32_bf16 a[28:31], v[92:95], v[44:47], a[28:31]
    ds_read_b128 v[44:47], v6 offset:30720
    s_waitcnt lgkmcnt(12)
    v_mfma_f32_16x16x32_bf16 a[32:35], v[80:83], v[24:27], a[32:35]
    ds_read_b64_tr_b16 v[48:49], v2 offset:36864
    v_mfma_f32_16x16x32_bf16 a[36:39], v[84:87], v[24:27], a[36:39]
    ds_read_b64_tr_b16 v[50:51], v2 offset:37376
    v_mfma_f32_16x16x32_bf16 a[40:43], v[88:91], v[24:27], a[40:43]
    v_mfma_f32_16x16x32_bf16 a[44:47], v[92:95], v[24:27], a[44:47]
    ds_read_b128 v[24:27], v7 offset:16384
    s_waitcnt lgkmcnt(12)
    v_mfma_f32_16x16x32_bf16 a[48:51], v[80:83], v[28:31], a[48:51]
    ds_read_b64_tr_b16 v[52:53], v3 offset:36864
    v_mfma_f32_16x16x32_bf16 a[52:55], v[84:87], v[28:31], a[52:55]
    ds_read_b64_tr_b16 v[54:55], v3 offset:37376
    v_mfma_f32_16x16x32_bf16 a[56:59], v[88:91], v[28:31], a[56:59]
    v_mfma_f32_16x16x32_bf16 a[60:63], v[92:95], v[28:31], a[60:63]
    ds_read_b128 v[28:31], v7 offset:18432
    s_waitcnt lgkmcnt(13)
    v_mfma_f32_16x16x32_bf16 a[64:67], v[80:83], v[32:35], a[64:67]
    ds_read_b64_tr_b16 v[56:57], v4 offset:36864
    v_mfma_f32_16x16x32_bf16 a[68:71], v[84:87], v[32:35], a[68:71]
    v_mfma_f32_16x16x32_bf16 a[72:75], v[88:91], v[32:35], a[72:75]
    v_mfma_f32_16x16x32_bf16 a[76:79], v[92:95], v[32:35], a[76:79]
    ds_read_b128 v[32:35], v7 offset:20480
    s_waitcnt lgkmcnt(12)
    v_mfma_f32_16x16x32_bf16 a[80:83], v[80:83], v[36:39], a[80:83]
    ds_read_b64_tr_b16 v[58:59], v4 offset:37376
    v_mfma_f32_16x16x32_bf16 a[84:87], v[84:87], v[36:39], a[84:87]
    ds_read_b64_tr_b16 v[60:61], v5 offset:36864
    v_mfma_f32_16x16x32_bf16 a[88:91], v[88:91], v[36:39], a[88:91]
    v_mfma_f32_16x16x32_bf16 a[92:95], v[92:95], v[36:39], a[92:95]
    ds_read_b128 v[36:39], v7 offset:22528
    s_waitcnt lgkmcnt(12)
    v_mfma_f32_16x16x32_bf16 a[96:99], v[80:83], v[40:43], a[96:99]
    ds_read_b64_tr_b16 v[62:63], v5 offset:37376
    v_mfma_f32_16x16x32_bf16 a[100:103], v[84:87], v[40:43], a[100:103]
    v_mfma_f32_16x16x32_bf16 a[104:107], v[88:91], v[40:43], a[104:107]
    v_mfma_f32_16x16x32_bf16 a[108:111], v[92:95], v[40:43], a[108:111]
    ds_read_b128 v[40:43], v7 offset:24576
    s_waitcnt lgkmcnt(13)
    v_mfma_f32_16x16x32_bf16 a[112:115], v[80:83], v[44:47], a[112:115]
    v_mfma_f32_16x16x32_bf16 a[116:119], v[84:87], v[44:47], a[116:119]
    v_mfma_f32_16x16x32_bf16 a[120:123], v[88:91], v[44:47], a[120:123]
    v_mfma_f32_16x16x32_bf16 a[124:127], v[92:95], v[44:47], a[124:127]
    ds_read_b128 v[44:47], v7 offset:26624
    s_waitcnt lgkmcnt(11)
    v_mfma_f32_16x16x32_bf16 a[0:3], v[96:99], v[24:27], a[0:3]
    v_mfma_f32_16x16x32_bf16 a[4:7], v[100:103], v[24:27], a[4:7]
    v_mfma_f32_16x16x32_bf16 a[8:11], v[104:107], v[24:27], a[8:11]
    v_mfma_f32_16x16x32_bf16 a[12:15], v[108:111], v[24:27], a[12:15]
    ds_read_b128 v[24:27], v7 offset:28672
    s_waitcnt lgkmcnt(9)
    v_mfma_f32_16x16x32_bf16 a[16:19], v[96:99], v[28:31], a[16:19]
    v_mfma_f32_16x16x32_bf16 a[20:23], v[100:103], v[28:31], a[20:23]
    v_mfma_f32_16x16x32_bf16 a[24:27], v[104:107], v[28:31], a[24:27]
    v_mfma_f32_16x16x32_bf16 a[28:31], v[108:111], v[28:31], a[28:31]
    ds_read_b128 v[28:31], v7 offset:30720
    s_waitcnt lgkmcnt(8)
    v_mfma_f32_16x16x32_bf16 a[32:35], v[96:99], v[32:35], a[32:35]
    v_mfma_f32_16x16x32_bf16 a[36:39], v[100:103], v[32:35], a[36:39]
    v_mfma_f32_16x16x32_bf16 a[40:43], v[104:107], v[32:35], a[40:43]
    v_mfma_f32_16x16x32_bf16 a[44:47], v[108:111], v[32:35], a[44:47]
    s_waitcnt lgkmcnt(4)
    s_barrier
    ds_read_b128 v[32:35], v6 offset:32768
    v_mfma_f32_16x16x32_bf16 a[48:51], v[96:99], v[36:39], a[48:51]
    v_mfma_f32_16x16x32_bf16 a[52:55], v[100:103], v[36:39], a[52:55]
    v_mfma_f32_16x16x32_bf16 a[56:59], v[104:107], v[36:39], a[56:59]
    v_mfma_f32_16x16x32_bf16 a[60:63], v[108:111], v[36:39], a[60:63]
    ds_read_b128 v[36:39], v6 offset:34816
    s_waitcnt lgkmcnt(5)
    v_mfma_f32_16x16x32_bf16 a[64:67], v[96:99], v[40:43], a[64:67]
    v_add_u32 v2, 4294934528, v2
    v_add_u32 v3, 4294934528, v3
    v_add_u32 v4, 4294934528, v4
    v_add_u32 v5, 4294934528, v5
    v_mfma_f32_16x16x32_bf16 a[68:71], v[100:103], v[40:43], a[68:71]
    ds_read_b64_tr_b16 v[64:65], v2 offset:0
    v_mfma_f32_16x16x32_bf16 a[72:75], v[104:107], v[40:43], a[72:75]
    v_mfma_f32_16x16x32_bf16 a[76:79], v[108:111], v[40:43], a[76:79]
    ds_read_b128 v[40:43], v6 offset:36864
    s_waitcnt lgkmcnt(6)
    v_mfma_f32_16x16x32_bf16 a[80:83], v[96:99], v[44:47], a[80:83]
    ds_read_b64_tr_b16 v[66:67], v2 offset:512
    v_mfma_f32_16x16x32_bf16 a[84:87], v[100:103], v[44:47], a[84:87]
    ds_read_b64_tr_b16 v[68:69], v3 offset:0
    v_mfma_f32_16x16x32_bf16 a[88:91], v[104:107], v[44:47], a[88:91]
    v_mfma_f32_16x16x32_bf16 a[92:95], v[108:111], v[44:47], a[92:95]
    ds_read_b128 v[44:47], v6 offset:38912
    s_waitcnt lgkmcnt(8)
    v_mfma_f32_16x16x32_bf16 a[96:99], v[96:99], v[24:27], a[96:99]
    ds_read_b64_tr_b16 v[70:71], v3 offset:512
    v_mfma_f32_16x16x32_bf16 a[100:103], v[100:103], v[24:27], a[100:103]
    v_mfma_f32_16x16x32_bf16 a[104:107], v[104:107], v[24:27], a[104:107]
    v_mfma_f32_16x16x32_bf16 a[108:111], v[108:111], v[24:27], a[108:111]
    ds_read_b128 v[24:27], v6 offset:40960
    s_waitcnt lgkmcnt(9)
    v_mfma_f32_16x16x32_bf16 a[112:115], v[96:99], v[28:31], a[112:115]
    ds_read_b64_tr_b16 v[72:73], v4 offset:0
    v_mfma_f32_16x16x32_bf16 a[116:119], v[100:103], v[28:31], a[116:119]
    ds_read_b64_tr_b16 v[74:75], v4 offset:512
    v_mfma_f32_16x16x32_bf16 a[120:123], v[104:107], v[28:31], a[120:123]
    v_mfma_f32_16x16x32_bf16 a[124:127], v[108:111], v[28:31], a[124:127]
    ds_read_b128 v[28:31], v6 offset:43008
    s_waitcnt lgkmcnt(11)
    v_mfma_f32_16x16x32_bf16 a[0:3], v[112:115], v[32:35], a[0:3]
    ds_read_b64_tr_b16 v[76:77], v5 offset:0
    v_mfma_f32_16x16x32_bf16 a[4:7], v[116:119], v[32:35], a[4:7]
    ds_read_b64_tr_b16 v[78:79], v5 offset:512
    v_mfma_f32_16x16x32_bf16 a[8:11], v[120:123], v[32:35], a[8:11]
    v_mfma_f32_16x16x32_bf16 a[12:15], v[124:127], v[32:35], a[12:15]
    ds_read_b128 v[32:35], v6 offset:45056
    s_waitcnt lgkmcnt(13)
    v_mfma_f32_16x16x32_bf16 a[16:19], v[112:115], v[36:39], a[16:19]
    v_mfma_f32_16x16x32_bf16 a[20:23], v[116:119], v[36:39], a[20:23]
    v_mfma_f32_16x16x32_bf16 a[24:27], v[120:123], v[36:39], a[24:27]
    v_mfma_f32_16x16x32_bf16 a[28:31], v[124:127], v[36:39], a[28:31]
    ds_read_b128 v[36:39], v6 offset:47104
    s_waitcnt lgkmcnt(12)
    v_mfma_f32_16x16x32_bf16 a[32:35], v[112:115], v[40:43], a[32:35]
    ds_read_b64_tr_b16 v[80:81], v2 offset:4096
    v_mfma_f32_16x16x32_bf16 a[36:39], v[116:119], v[40:43], a[36:39]
    ds_read_b64_tr_b16 v[82:83], v2 offset:4608
    v_mfma_f32_16x16x32_bf16 a[40:43], v[120:123], v[40:43], a[40:43]
    v_mfma_f32_16x16x32_bf16 a[44:47], v[124:127], v[40:43], a[44:47]
    ds_read_b128 v[40:43], v7 offset:32768
    s_waitcnt lgkmcnt(12)
    v_mfma_f32_16x16x32_bf16 a[48:51], v[112:115], v[44:47], a[48:51]
    ds_read_b64_tr_b16 v[84:85], v3 offset:4096
    v_mfma_f32_16x16x32_bf16 a[52:55], v[116:119], v[44:47], a[52:55]
    ds_read_b64_tr_b16 v[86:87], v3 offset:4608
    v_mfma_f32_16x16x32_bf16 a[56:59], v[120:123], v[44:47], a[56:59]
    v_mfma_f32_16x16x32_bf16 a[60:63], v[124:127], v[44:47], a[60:63]
    ds_read_b128 v[44:47], v7 offset:34816
    s_waitcnt lgkmcnt(13)
    v_mfma_f32_16x16x32_bf16 a[64:67], v[112:115], v[24:27], a[64:67]
    ds_read_b64_tr_b16 v[88:89], v4 offset:4096
    v_mfma_f32_16x16x32_bf16 a[68:71], v[116:119], v[24:27], a[68:71]
    v_mfma_f32_16x16x32_bf16 a[72:75], v[120:123], v[24:27], a[72:75]
    v_mfma_f32_16x16x32_bf16 a[76:79], v[124:127], v[24:27], a[76:79]
    ds_read_b128 v[24:27], v7 offset:36864
    s_waitcnt lgkmcnt(12)
    v_mfma_f32_16x16x32_bf16 a[80:83], v[112:115], v[28:31], a[80:83]
    ds_read_b64_tr_b16 v[90:91], v4 offset:4608
    v_mfma_f32_16x16x32_bf16 a[84:87], v[116:119], v[28:31], a[84:87]
    ds_read_b64_tr_b16 v[92:93], v5 offset:4096
    v_mfma_f32_16x16x32_bf16 a[88:91], v[120:123], v[28:31], a[88:91]
    v_mfma_f32_16x16x32_bf16 a[92:95], v[124:127], v[28:31], a[92:95]
    ds_read_b128 v[28:31], v7 offset:38912
    s_waitcnt lgkmcnt(12)
    v_mfma_f32_16x16x32_bf16 a[96:99], v[112:115], v[32:35], a[96:99]
    ds_read_b64_tr_b16 v[94:95], v5 offset:4608
    v_mfma_f32_16x16x32_bf16 a[100:103], v[116:119], v[32:35], a[100:103]
    v_mfma_f32_16x16x32_bf16 a[104:107], v[120:123], v[32:35], a[104:107]
    v_mfma_f32_16x16x32_bf16 a[108:111], v[124:127], v[32:35], a[108:111]
    ds_read_b128 v[32:35], v7 offset:40960
    s_waitcnt lgkmcnt(13)
    v_mfma_f32_16x16x32_bf16 a[112:115], v[112:115], v[36:39], a[112:115]
    v_mfma_f32_16x16x32_bf16 a[116:119], v[116:119], v[36:39], a[116:119]
    v_mfma_f32_16x16x32_bf16 a[120:123], v[120:123], v[36:39], a[120:123]
    v_mfma_f32_16x16x32_bf16 a[124:127], v[124:127], v[36:39], a[124:127]
    ds_read_b128 v[36:39], v7 offset:43008
    s_waitcnt lgkmcnt(11)
    v_mfma_f32_16x16x32_bf16 a[0:3], v[48:51], v[40:43], a[0:3]
    v_mfma_f32_16x16x32_bf16 a[4:7], v[52:55], v[40:43], a[4:7]
    v_mfma_f32_16x16x32_bf16 a[8:11], v[56:59], v[40:43], a[8:11]
    v_mfma_f32_16x16x32_bf16 a[12:15], v[60:63], v[40:43], a[12:15]
    ds_read_b128 v[40:43], v7 offset:45056
    s_waitcnt lgkmcnt(9)
    v_mfma_f32_16x16x32_bf16 a[16:19], v[48:51], v[44:47], a[16:19]
    v_mfma_f32_16x16x32_bf16 a[20:23], v[52:55], v[44:47], a[20:23]
    v_mfma_f32_16x16x32_bf16 a[24:27], v[56:59], v[44:47], a[24:27]
    v_mfma_f32_16x16x32_bf16 a[28:31], v[60:63], v[44:47], a[28:31]
    ds_read_b128 v[44:47], v7 offset:47104
    s_waitcnt lgkmcnt(8)
    v_mfma_f32_16x16x32_bf16 a[32:35], v[48:51], v[24:27], a[32:35]
    v_mfma_f32_16x16x32_bf16 a[36:39], v[52:55], v[24:27], a[36:39]
    v_mfma_f32_16x16x32_bf16 a[40:43], v[56:59], v[24:27], a[40:43]
    v_mfma_f32_16x16x32_bf16 a[44:47], v[60:63], v[24:27], a[44:47]
    s_waitcnt lgkmcnt(4)
    s_barrier
    ds_read_b128 v[24:27], v6 offset:49152
    v_mfma_f32_16x16x32_bf16 a[48:51], v[48:51], v[28:31], a[48:51]
    v_mfma_f32_16x16x32_bf16 a[52:55], v[52:55], v[28:31], a[52:55]
    v_mfma_f32_16x16x32_bf16 a[56:59], v[56:59], v[28:31], a[56:59]
    v_mfma_f32_16x16x32_bf16 a[60:63], v[60:63], v[28:31], a[60:63]
    ds_read_b128 v[28:31], v6 offset:51200
    s_waitcnt lgkmcnt(5)
    v_mfma_f32_16x16x32_bf16 a[64:67], v[48:51], v[32:35], a[64:67]
    v_mfma_f32_16x16x32_bf16 a[68:71], v[52:55], v[32:35], a[68:71]
    ds_read_b64_tr_b16 v[96:97], v2 offset:32768
    v_mfma_f32_16x16x32_bf16 a[72:75], v[56:59], v[32:35], a[72:75]
    v_mfma_f32_16x16x32_bf16 a[76:79], v[60:63], v[32:35], a[76:79]
    ds_read_b128 v[32:35], v6 offset:53248
    s_waitcnt lgkmcnt(6)
    v_mfma_f32_16x16x32_bf16 a[80:83], v[48:51], v[36:39], a[80:83]
    ds_read_b64_tr_b16 v[98:99], v2 offset:33280
    v_mfma_f32_16x16x32_bf16 a[84:87], v[52:55], v[36:39], a[84:87]
    ds_read_b64_tr_b16 v[100:101], v3 offset:32768
    v_mfma_f32_16x16x32_bf16 a[88:91], v[56:59], v[36:39], a[88:91]
    v_mfma_f32_16x16x32_bf16 a[92:95], v[60:63], v[36:39], a[92:95]
    ds_read_b128 v[36:39], v6 offset:55296
    s_waitcnt lgkmcnt(8)
    v_mfma_f32_16x16x32_bf16 a[96:99], v[48:51], v[40:43], a[96:99]
    ds_read_b64_tr_b16 v[102:103], v3 offset:33280
    v_mfma_f32_16x16x32_bf16 a[100:103], v[52:55], v[40:43], a[100:103]
    v_mfma_f32_16x16x32_bf16 a[104:107], v[56:59], v[40:43], a[104:107]
    v_mfma_f32_16x16x32_bf16 a[108:111], v[60:63], v[40:43], a[108:111]
    ds_read_b128 v[40:43], v6 offset:57344
    s_waitcnt lgkmcnt(9)
    v_mfma_f32_16x16x32_bf16 a[112:115], v[48:51], v[44:47], a[112:115]
    ds_read_b64_tr_b16 v[104:105], v4 offset:32768
    v_mfma_f32_16x16x32_bf16 a[116:119], v[52:55], v[44:47], a[116:119]
    ds_read_b64_tr_b16 v[106:107], v4 offset:33280
    v_mfma_f32_16x16x32_bf16 a[120:123], v[56:59], v[44:47], a[120:123]
    v_mfma_f32_16x16x32_bf16 a[124:127], v[60:63], v[44:47], a[124:127]
    ds_read_b128 v[44:47], v6 offset:59392
    s_waitcnt lgkmcnt(11)
    v_mfma_f32_16x16x32_bf16 a[0:3], v[64:67], v[24:27], a[0:3]
    ds_read_b64_tr_b16 v[108:109], v5 offset:32768
    v_mfma_f32_16x16x32_bf16 a[4:7], v[68:71], v[24:27], a[4:7]
    ds_read_b64_tr_b16 v[110:111], v5 offset:33280
    v_mfma_f32_16x16x32_bf16 a[8:11], v[72:75], v[24:27], a[8:11]
    v_mfma_f32_16x16x32_bf16 a[12:15], v[76:79], v[24:27], a[12:15]
    ds_read_b128 v[24:27], v6 offset:61440
    s_waitcnt lgkmcnt(13)
    v_mfma_f32_16x16x32_bf16 a[16:19], v[64:67], v[28:31], a[16:19]
    v_mfma_f32_16x16x32_bf16 a[20:23], v[68:71], v[28:31], a[20:23]
    v_mfma_f32_16x16x32_bf16 a[24:27], v[72:75], v[28:31], a[24:27]
    v_mfma_f32_16x16x32_bf16 a[28:31], v[76:79], v[28:31], a[28:31]
    ds_read_b128 v[28:31], v6 offset:63488
    s_waitcnt lgkmcnt(12)
    v_mfma_f32_16x16x32_bf16 a[32:35], v[64:67], v[32:35], a[32:35]
    ds_read_b64_tr_b16 v[112:113], v2 offset:36864
    v_mfma_f32_16x16x32_bf16 a[36:39], v[68:71], v[32:35], a[36:39]
    ds_read_b64_tr_b16 v[114:115], v2 offset:37376
    v_mfma_f32_16x16x32_bf16 a[40:43], v[72:75], v[32:35], a[40:43]
    v_mfma_f32_16x16x32_bf16 a[44:47], v[76:79], v[32:35], a[44:47]
    ds_read_b128 v[32:35], v7 offset:49152
    s_waitcnt lgkmcnt(12)
    v_mfma_f32_16x16x32_bf16 a[48:51], v[64:67], v[36:39], a[48:51]
    ds_read_b64_tr_b16 v[116:117], v3 offset:36864
    v_mfma_f32_16x16x32_bf16 a[52:55], v[68:71], v[36:39], a[52:55]
    ds_read_b64_tr_b16 v[118:119], v3 offset:37376
    v_mfma_f32_16x16x32_bf16 a[56:59], v[72:75], v[36:39], a[56:59]
    v_mfma_f32_16x16x32_bf16 a[60:63], v[76:79], v[36:39], a[60:63]
    ds_read_b128 v[36:39], v7 offset:51200
    s_waitcnt lgkmcnt(13)
    v_mfma_f32_16x16x32_bf16 a[64:67], v[64:67], v[40:43], a[64:67]
    ds_read_b64_tr_b16 v[120:121], v4 offset:36864
    v_mfma_f32_16x16x32_bf16 a[68:71], v[68:71], v[40:43], a[68:71]
    v_mfma_f32_16x16x32_bf16 a[72:75], v[72:75], v[40:43], a[72:75]
    v_mfma_f32_16x16x32_bf16 a[76:79], v[76:79], v[40:43], a[76:79]
    ds_read_b128 v[40:43], v7 offset:53248
    s_waitcnt lgkmcnt(12)
    v_mfma_f32_16x16x32_bf16 a[80:83], v[64:67], v[44:47], a[80:83]
    ds_read_b64_tr_b16 v[122:123], v4 offset:37376
    v_mfma_f32_16x16x32_bf16 a[84:87], v[68:71], v[44:47], a[84:87]
    ds_read_b64_tr_b16 v[124:125], v5 offset:36864
    v_mfma_f32_16x16x32_bf16 a[88:91], v[72:75], v[44:47], a[88:91]
    v_mfma_f32_16x16x32_bf16 a[92:95], v[76:79], v[44:47], a[92:95]
    ds_read_b128 v[44:47], v7 offset:55296
    s_waitcnt lgkmcnt(12)
    v_mfma_f32_16x16x32_bf16 a[96:99], v[64:67], v[24:27], a[96:99]
    ds_read_b64_tr_b16 v[126:127], v5 offset:37376
    v_mfma_f32_16x16x32_bf16 a[100:103], v[68:71], v[24:27], a[100:103]
    v_mfma_f32_16x16x32_bf16 a[104:107], v[72:75], v[24:27], a[104:107]
    v_mfma_f32_16x16x32_bf16 a[108:111], v[76:79], v[24:27], a[108:111]
    ds_read_b128 v[24:27], v7 offset:57344
    s_waitcnt lgkmcnt(13)
    v_mfma_f32_16x16x32_bf16 a[112:115], v[64:67], v[28:31], a[112:115]
    v_mfma_f32_16x16x32_bf16 a[116:119], v[68:71], v[28:31], a[116:119]
    v_mfma_f32_16x16x32_bf16 a[120:123], v[72:75], v[28:31], a[120:123]
    v_mfma_f32_16x16x32_bf16 a[124:127], v[76:79], v[28:31], a[124:127]
    ds_read_b128 v[28:31], v7 offset:59392
    s_waitcnt lgkmcnt(11)
    v_mfma_f32_16x16x32_bf16 a[0:3], v[80:83], v[32:35], a[0:3]
    v_mfma_f32_16x16x32_bf16 a[4:7], v[84:87], v[32:35], a[4:7]
    v_mfma_f32_16x16x32_bf16 a[8:11], v[88:91], v[32:35], a[8:11]
    v_mfma_f32_16x16x32_bf16 a[12:15], v[92:95], v[32:35], a[12:15]
    ds_read_b128 v[32:35], v7 offset:61440
    s_waitcnt lgkmcnt(9)
    v_mfma_f32_16x16x32_bf16 a[16:19], v[80:83], v[36:39], a[16:19]
    v_mfma_f32_16x16x32_bf16 a[20:23], v[84:87], v[36:39], a[20:23]
    v_mfma_f32_16x16x32_bf16 a[24:27], v[88:91], v[36:39], a[24:27]
    v_mfma_f32_16x16x32_bf16 a[28:31], v[92:95], v[36:39], a[28:31]
    ds_read_b128 v[36:39], v7 offset:63488
    s_waitcnt lgkmcnt(8)
    v_mfma_f32_16x16x32_bf16 a[32:35], v[80:83], v[40:43], a[32:35]
    v_mfma_f32_16x16x32_bf16 a[36:39], v[84:87], v[40:43], a[36:39]
    v_mfma_f32_16x16x32_bf16 a[40:43], v[88:91], v[40:43], a[40:43]
    v_mfma_f32_16x16x32_bf16 a[44:47], v[92:95], v[40:43], a[44:47]
    s_waitcnt lgkmcnt(4)
    s_barrier
    ds_read_b128 v[40:43], v6 offset:0
    v_mfma_f32_16x16x32_bf16 a[48:51], v[80:83], v[44:47], a[48:51]
    v_mfma_f32_16x16x32_bf16 a[52:55], v[84:87], v[44:47], a[52:55]
    v_mfma_f32_16x16x32_bf16 a[56:59], v[88:91], v[44:47], a[56:59]
    v_mfma_f32_16x16x32_bf16 a[60:63], v[92:95], v[44:47], a[60:63]
    ds_read_b128 v[44:47], v6 offset:2048
    s_waitcnt lgkmcnt(5)
    v_mfma_f32_16x16x32_bf16 a[64:67], v[80:83], v[24:27], a[64:67]
    v_add_u32 v2, 32768, v2
    v_add_u32 v3, 32768, v3
    v_add_u32 v4, 32768, v4
    v_add_u32 v5, 32768, v5
    v_mfma_f32_16x16x32_bf16 a[68:71], v[84:87], v[24:27], a[68:71]
    ds_read_b64_tr_b16 v[48:49], v2 offset:32768
    v_mfma_f32_16x16x32_bf16 a[72:75], v[88:91], v[24:27], a[72:75]
    v_mfma_f32_16x16x32_bf16 a[76:79], v[92:95], v[24:27], a[76:79]
    ds_read_b128 v[24:27], v6 offset:4096
    s_waitcnt lgkmcnt(6)
    v_mfma_f32_16x16x32_bf16 a[80:83], v[80:83], v[28:31], a[80:83]
    ds_read_b64_tr_b16 v[50:51], v2 offset:33280
    v_mfma_f32_16x16x32_bf16 a[84:87], v[84:87], v[28:31], a[84:87]
    ds_read_b64_tr_b16 v[52:53], v3 offset:32768
    v_mfma_f32_16x16x32_bf16 a[88:91], v[88:91], v[28:31], a[88:91]
    v_mfma_f32_16x16x32_bf16 a[92:95], v[92:95], v[28:31], a[92:95]
    ds_read_b128 v[28:31], v6 offset:6144
    s_waitcnt lgkmcnt(8)
    v_mfma_f32_16x16x32_bf16 a[96:99], v[80:83], v[32:35], a[96:99]
    ds_read_b64_tr_b16 v[54:55], v3 offset:33280
    v_mfma_f32_16x16x32_bf16 a[100:103], v[84:87], v[32:35], a[100:103]
    v_mfma_f32_16x16x32_bf16 a[104:107], v[88:91], v[32:35], a[104:107]
    v_mfma_f32_16x16x32_bf16 a[108:111], v[92:95], v[32:35], a[108:111]
    ds_read_b128 v[32:35], v6 offset:8192
    s_waitcnt lgkmcnt(9)
    v_mfma_f32_16x16x32_bf16 a[112:115], v[80:83], v[36:39], a[112:115]
    ds_read_b64_tr_b16 v[56:57], v4 offset:32768
    v_mfma_f32_16x16x32_bf16 a[116:119], v[84:87], v[36:39], a[116:119]
    ds_read_b64_tr_b16 v[58:59], v4 offset:33280
    v_mfma_f32_16x16x32_bf16 a[120:123], v[88:91], v[36:39], a[120:123]
    v_mfma_f32_16x16x32_bf16 a[124:127], v[92:95], v[36:39], a[124:127]
    ds_read_b128 v[36:39], v6 offset:10240
    s_waitcnt lgkmcnt(11)
    v_mfma_f32_16x16x32_bf16 a[0:3], v[96:99], v[40:43], a[0:3]
    ds_read_b64_tr_b16 v[60:61], v5 offset:32768
    v_mfma_f32_16x16x32_bf16 a[4:7], v[100:103], v[40:43], a[4:7]
    ds_read_b64_tr_b16 v[62:63], v5 offset:33280
    v_mfma_f32_16x16x32_bf16 a[8:11], v[104:107], v[40:43], a[8:11]
    v_mfma_f32_16x16x32_bf16 a[12:15], v[108:111], v[40:43], a[12:15]
    ds_read_b128 v[40:43], v6 offset:12288
    s_waitcnt lgkmcnt(13)
    v_mfma_f32_16x16x32_bf16 a[16:19], v[96:99], v[44:47], a[16:19]
    v_mfma_f32_16x16x32_bf16 a[20:23], v[100:103], v[44:47], a[20:23]
    v_mfma_f32_16x16x32_bf16 a[24:27], v[104:107], v[44:47], a[24:27]
    v_mfma_f32_16x16x32_bf16 a[28:31], v[108:111], v[44:47], a[28:31]
    ds_read_b128 v[44:47], v6 offset:14336
    s_waitcnt lgkmcnt(12)
    v_mfma_f32_16x16x32_bf16 a[32:35], v[96:99], v[24:27], a[32:35]
    ds_read_b64_tr_b16 v[64:65], v2 offset:36864
    v_mfma_f32_16x16x32_bf16 a[36:39], v[100:103], v[24:27], a[36:39]
    ds_read_b64_tr_b16 v[66:67], v2 offset:37376
    v_mfma_f32_16x16x32_bf16 a[40:43], v[104:107], v[24:27], a[40:43]
    v_mfma_f32_16x16x32_bf16 a[44:47], v[108:111], v[24:27], a[44:47]
    ds_read_b128 v[24:27], v7 offset:0
    s_waitcnt lgkmcnt(12)
    v_mfma_f32_16x16x32_bf16 a[48:51], v[96:99], v[28:31], a[48:51]
    ds_read_b64_tr_b16 v[68:69], v3 offset:36864
    v_mfma_f32_16x16x32_bf16 a[52:55], v[100:103], v[28:31], a[52:55]
    ds_read_b64_tr_b16 v[70:71], v3 offset:37376
    v_mfma_f32_16x16x32_bf16 a[56:59], v[104:107], v[28:31], a[56:59]
    v_mfma_f32_16x16x32_bf16 a[60:63], v[108:111], v[28:31], a[60:63]
    ds_read_b128 v[28:31], v7 offset:2048
    s_waitcnt lgkmcnt(13)
    v_mfma_f32_16x16x32_bf16 a[64:67], v[96:99], v[32:35], a[64:67]
    ds_read_b64_tr_b16 v[72:73], v4 offset:36864
    v_mfma_f32_16x16x32_bf16 a[68:71], v[100:103], v[32:35], a[68:71]
    v_mfma_f32_16x16x32_bf16 a[72:75], v[104:107], v[32:35], a[72:75]
    v_mfma_f32_16x16x32_bf16 a[76:79], v[108:111], v[32:35], a[76:79]
    ds_read_b128 v[32:35], v7 offset:4096
    s_waitcnt lgkmcnt(12)
    v_mfma_f32_16x16x32_bf16 a[80:83], v[96:99], v[36:39], a[80:83]
    ds_read_b64_tr_b16 v[74:75], v4 offset:37376
    v_mfma_f32_16x16x32_bf16 a[84:87], v[100:103], v[36:39], a[84:87]
    ds_read_b64_tr_b16 v[76:77], v5 offset:36864
    v_mfma_f32_16x16x32_bf16 a[88:91], v[104:107], v[36:39], a[88:91]
    v_mfma_f32_16x16x32_bf16 a[92:95], v[108:111], v[36:39], a[92:95]
    ds_read_b128 v[36:39], v7 offset:6144
    s_waitcnt lgkmcnt(12)
    v_mfma_f32_16x16x32_bf16 a[96:99], v[96:99], v[40:43], a[96:99]
    ds_read_b64_tr_b16 v[78:79], v5 offset:37376
    v_mfma_f32_16x16x32_bf16 a[100:103], v[100:103], v[40:43], a[100:103]
    v_mfma_f32_16x16x32_bf16 a[104:107], v[104:107], v[40:43], a[104:107]
    v_mfma_f32_16x16x32_bf16 a[108:111], v[108:111], v[40:43], a[108:111]
    ds_read_b128 v[40:43], v7 offset:8192
    s_waitcnt lgkmcnt(13)
    v_mfma_f32_16x16x32_bf16 a[112:115], v[96:99], v[44:47], a[112:115]
    v_mfma_f32_16x16x32_bf16 a[116:119], v[100:103], v[44:47], a[116:119]
    v_mfma_f32_16x16x32_bf16 a[120:123], v[104:107], v[44:47], a[120:123]
    v_mfma_f32_16x16x32_bf16 a[124:127], v[108:111], v[44:47], a[124:127]
    ds_read_b128 v[44:47], v7 offset:10240
    s_waitcnt lgkmcnt(11)
    v_mfma_f32_16x16x32_bf16 a[0:3], v[112:115], v[24:27], a[0:3]
    v_mfma_f32_16x16x32_bf16 a[4:7], v[116:119], v[24:27], a[4:7]
    v_mfma_f32_16x16x32_bf16 a[8:11], v[120:123], v[24:27], a[8:11]
    v_mfma_f32_16x16x32_bf16 a[12:15], v[124:127], v[24:27], a[12:15]
    ds_read_b128 v[24:27], v7 offset:12288
    s_waitcnt lgkmcnt(9)
    v_mfma_f32_16x16x32_bf16 a[16:19], v[112:115], v[28:31], a[16:19]
    v_mfma_f32_16x16x32_bf16 a[20:23], v[116:119], v[28:31], a[20:23]
    v_mfma_f32_16x16x32_bf16 a[24:27], v[120:123], v[28:31], a[24:27]
    v_mfma_f32_16x16x32_bf16 a[28:31], v[124:127], v[28:31], a[28:31]
    ds_read_b128 v[28:31], v7 offset:14336
    s_waitcnt lgkmcnt(8)
    v_mfma_f32_16x16x32_bf16 a[32:35], v[112:115], v[32:35], a[32:35]
    v_mfma_f32_16x16x32_bf16 a[36:39], v[116:119], v[32:35], a[36:39]
    v_mfma_f32_16x16x32_bf16 a[40:43], v[120:123], v[32:35], a[40:43]
    v_mfma_f32_16x16x32_bf16 a[44:47], v[124:127], v[32:35], a[44:47]
    s_waitcnt lgkmcnt(4)
    s_barrier
    ds_read_b128 v[32:35], v6 offset:16384
    v_mfma_f32_16x16x32_bf16 a[48:51], v[112:115], v[36:39], a[48:51]
    v_mfma_f32_16x16x32_bf16 a[52:55], v[116:119], v[36:39], a[52:55]
    v_mfma_f32_16x16x32_bf16 a[56:59], v[120:123], v[36:39], a[56:59]
    v_mfma_f32_16x16x32_bf16 a[60:63], v[124:127], v[36:39], a[60:63]
    ds_read_b128 v[36:39], v6 offset:18432
    s_waitcnt lgkmcnt(5)
    v_mfma_f32_16x16x32_bf16 a[64:67], v[112:115], v[40:43], a[64:67]
    v_add_u32 v2, 4294934528, v2
    v_add_u32 v3, 4294934528, v3
    v_add_u32 v4, 4294934528, v4
    v_add_u32 v5, 4294934528, v5
    v_mfma_f32_16x16x32_bf16 a[68:71], v[116:119], v[40:43], a[68:71]
    ds_read_b64_tr_b16 v[80:81], v2 offset:0
    v_mfma_f32_16x16x32_bf16 a[72:75], v[120:123], v[40:43], a[72:75]
    v_mfma_f32_16x16x32_bf16 a[76:79], v[124:127], v[40:43], a[76:79]
    ds_read_b128 v[40:43], v6 offset:20480
    s_waitcnt lgkmcnt(6)
    v_mfma_f32_16x16x32_bf16 a[80:83], v[112:115], v[44:47], a[80:83]
    ds_read_b64_tr_b16 v[82:83], v2 offset:512
    v_mfma_f32_16x16x32_bf16 a[84:87], v[116:119], v[44:47], a[84:87]
    ds_read_b64_tr_b16 v[84:85], v3 offset:0
    v_mfma_f32_16x16x32_bf16 a[88:91], v[120:123], v[44:47], a[88:91]
    v_mfma_f32_16x16x32_bf16 a[92:95], v[124:127], v[44:47], a[92:95]
    ds_read_b128 v[44:47], v6 offset:22528
    s_waitcnt lgkmcnt(8)
    v_mfma_f32_16x16x32_bf16 a[96:99], v[112:115], v[24:27], a[96:99]
    ds_read_b64_tr_b16 v[86:87], v3 offset:512
    v_mfma_f32_16x16x32_bf16 a[100:103], v[116:119], v[24:27], a[100:103]
    v_mfma_f32_16x16x32_bf16 a[104:107], v[120:123], v[24:27], a[104:107]
    v_mfma_f32_16x16x32_bf16 a[108:111], v[124:127], v[24:27], a[108:111]
    ds_read_b128 v[24:27], v6 offset:24576
    s_waitcnt lgkmcnt(9)
    v_mfma_f32_16x16x32_bf16 a[112:115], v[112:115], v[28:31], a[112:115]
    ds_read_b64_tr_b16 v[88:89], v4 offset:0
    v_mfma_f32_16x16x32_bf16 a[116:119], v[116:119], v[28:31], a[116:119]
    ds_read_b64_tr_b16 v[90:91], v4 offset:512
    v_mfma_f32_16x16x32_bf16 a[120:123], v[120:123], v[28:31], a[120:123]
    v_mfma_f32_16x16x32_bf16 a[124:127], v[124:127], v[28:31], a[124:127]
    ds_read_b128 v[28:31], v6 offset:26624
    s_waitcnt lgkmcnt(11)
    v_mfma_f32_16x16x32_bf16 a[0:3], v[48:51], v[32:35], a[0:3]
    ds_read_b64_tr_b16 v[92:93], v5 offset:0
    v_mfma_f32_16x16x32_bf16 a[4:7], v[52:55], v[32:35], a[4:7]
    ds_read_b64_tr_b16 v[94:95], v5 offset:512
    v_mfma_f32_16x16x32_bf16 a[8:11], v[56:59], v[32:35], a[8:11]
    v_mfma_f32_16x16x32_bf16 a[12:15], v[60:63], v[32:35], a[12:15]
    ds_read_b128 v[32:35], v6 offset:28672
    s_waitcnt lgkmcnt(13)
    v_mfma_f32_16x16x32_bf16 a[16:19], v[48:51], v[36:39], a[16:19]
    v_mfma_f32_16x16x32_bf16 a[20:23], v[52:55], v[36:39], a[20:23]
    v_mfma_f32_16x16x32_bf16 a[24:27], v[56:59], v[36:39], a[24:27]
    v_mfma_f32_16x16x32_bf16 a[28:31], v[60:63], v[36:39], a[28:31]
    ds_read_b128 v[36:39], v6 offset:30720
    s_waitcnt lgkmcnt(12)
    v_mfma_f32_16x16x32_bf16 a[32:35], v[48:51], v[40:43], a[32:35]
    ds_read_b64_tr_b16 v[96:97], v2 offset:4096
    v_mfma_f32_16x16x32_bf16 a[36:39], v[52:55], v[40:43], a[36:39]
    ds_read_b64_tr_b16 v[98:99], v2 offset:4608
    v_mfma_f32_16x16x32_bf16 a[40:43], v[56:59], v[40:43], a[40:43]
    v_mfma_f32_16x16x32_bf16 a[44:47], v[60:63], v[40:43], a[44:47]
    ds_read_b128 v[40:43], v7 offset:16384
    s_waitcnt lgkmcnt(12)
    v_mfma_f32_16x16x32_bf16 a[48:51], v[48:51], v[44:47], a[48:51]
    ds_read_b64_tr_b16 v[100:101], v3 offset:4096
    v_mfma_f32_16x16x32_bf16 a[52:55], v[52:55], v[44:47], a[52:55]
    ds_read_b64_tr_b16 v[102:103], v3 offset:4608
    v_mfma_f32_16x16x32_bf16 a[56:59], v[56:59], v[44:47], a[56:59]
    v_mfma_f32_16x16x32_bf16 a[60:63], v[60:63], v[44:47], a[60:63]
    ds_read_b128 v[44:47], v7 offset:18432
    s_waitcnt lgkmcnt(13)
    v_mfma_f32_16x16x32_bf16 a[64:67], v[48:51], v[24:27], a[64:67]
    ds_read_b64_tr_b16 v[104:105], v4 offset:4096
    v_mfma_f32_16x16x32_bf16 a[68:71], v[52:55], v[24:27], a[68:71]
    v_mfma_f32_16x16x32_bf16 a[72:75], v[56:59], v[24:27], a[72:75]
    v_mfma_f32_16x16x32_bf16 a[76:79], v[60:63], v[24:27], a[76:79]
    ds_read_b128 v[24:27], v7 offset:20480
    s_waitcnt lgkmcnt(12)
    v_mfma_f32_16x16x32_bf16 a[80:83], v[48:51], v[28:31], a[80:83]
    ds_read_b64_tr_b16 v[106:107], v4 offset:4608
    v_mfma_f32_16x16x32_bf16 a[84:87], v[52:55], v[28:31], a[84:87]
    ds_read_b64_tr_b16 v[108:109], v5 offset:4096
    v_mfma_f32_16x16x32_bf16 a[88:91], v[56:59], v[28:31], a[88:91]
    v_mfma_f32_16x16x32_bf16 a[92:95], v[60:63], v[28:31], a[92:95]
    ds_read_b128 v[28:31], v7 offset:22528
    s_waitcnt lgkmcnt(12)
    v_mfma_f32_16x16x32_bf16 a[96:99], v[48:51], v[32:35], a[96:99]
    ds_read_b64_tr_b16 v[110:111], v5 offset:4608
    v_mfma_f32_16x16x32_bf16 a[100:103], v[52:55], v[32:35], a[100:103]
    v_mfma_f32_16x16x32_bf16 a[104:107], v[56:59], v[32:35], a[104:107]
    v_mfma_f32_16x16x32_bf16 a[108:111], v[60:63], v[32:35], a[108:111]
    ds_read_b128 v[32:35], v7 offset:24576
    s_waitcnt lgkmcnt(13)
    v_mfma_f32_16x16x32_bf16 a[112:115], v[48:51], v[36:39], a[112:115]
    v_mfma_f32_16x16x32_bf16 a[116:119], v[52:55], v[36:39], a[116:119]
    v_mfma_f32_16x16x32_bf16 a[120:123], v[56:59], v[36:39], a[120:123]
    v_mfma_f32_16x16x32_bf16 a[124:127], v[60:63], v[36:39], a[124:127]
    ds_read_b128 v[36:39], v7 offset:26624
    s_waitcnt lgkmcnt(11)
    v_mfma_f32_16x16x32_bf16 a[0:3], v[64:67], v[40:43], a[0:3]
    v_mfma_f32_16x16x32_bf16 a[4:7], v[68:71], v[40:43], a[4:7]
    v_mfma_f32_16x16x32_bf16 a[8:11], v[72:75], v[40:43], a[8:11]
    v_mfma_f32_16x16x32_bf16 a[12:15], v[76:79], v[40:43], a[12:15]
    ds_read_b128 v[40:43], v7 offset:28672
    s_waitcnt lgkmcnt(9)
    v_mfma_f32_16x16x32_bf16 a[16:19], v[64:67], v[44:47], a[16:19]
    v_mfma_f32_16x16x32_bf16 a[20:23], v[68:71], v[44:47], a[20:23]
    v_mfma_f32_16x16x32_bf16 a[24:27], v[72:75], v[44:47], a[24:27]
    v_mfma_f32_16x16x32_bf16 a[28:31], v[76:79], v[44:47], a[28:31]
    ds_read_b128 v[44:47], v7 offset:30720
    s_waitcnt lgkmcnt(8)
    v_mfma_f32_16x16x32_bf16 a[32:35], v[64:67], v[24:27], a[32:35]
    v_mfma_f32_16x16x32_bf16 a[36:39], v[68:71], v[24:27], a[36:39]
    v_mfma_f32_16x16x32_bf16 a[40:43], v[72:75], v[24:27], a[40:43]
    v_mfma_f32_16x16x32_bf16 a[44:47], v[76:79], v[24:27], a[44:47]
    s_waitcnt lgkmcnt(4)
    s_barrier
    ds_read_b128 v[24:27], v6 offset:32768
    v_mfma_f32_16x16x32_bf16 a[48:51], v[64:67], v[28:31], a[48:51]
    v_mfma_f32_16x16x32_bf16 a[52:55], v[68:71], v[28:31], a[52:55]
    v_mfma_f32_16x16x32_bf16 a[56:59], v[72:75], v[28:31], a[56:59]
    v_mfma_f32_16x16x32_bf16 a[60:63], v[76:79], v[28:31], a[60:63]
    ds_read_b128 v[28:31], v6 offset:34816
    s_waitcnt lgkmcnt(5)
    v_mfma_f32_16x16x32_bf16 a[64:67], v[64:67], v[32:35], a[64:67]
    v_mfma_f32_16x16x32_bf16 a[68:71], v[68:71], v[32:35], a[68:71]
    ds_read_b64_tr_b16 v[112:113], v2 offset:32768
    v_mfma_f32_16x16x32_bf16 a[72:75], v[72:75], v[32:35], a[72:75]
    v_mfma_f32_16x16x32_bf16 a[76:79], v[76:79], v[32:35], a[76:79]
    ds_read_b128 v[32:35], v6 offset:36864
    s_waitcnt lgkmcnt(6)
    v_mfma_f32_16x16x32_bf16 a[80:83], v[64:67], v[36:39], a[80:83]
    ds_read_b64_tr_b16 v[114:115], v2 offset:33280
    v_mfma_f32_16x16x32_bf16 a[84:87], v[68:71], v[36:39], a[84:87]
    ds_read_b64_tr_b16 v[116:117], v3 offset:32768
    v_mfma_f32_16x16x32_bf16 a[88:91], v[72:75], v[36:39], a[88:91]
    v_mfma_f32_16x16x32_bf16 a[92:95], v[76:79], v[36:39], a[92:95]
    ds_read_b128 v[36:39], v6 offset:38912
    s_waitcnt lgkmcnt(8)
    v_mfma_f32_16x16x32_bf16 a[96:99], v[64:67], v[40:43], a[96:99]
    ds_read_b64_tr_b16 v[118:119], v3 offset:33280
    v_mfma_f32_16x16x32_bf16 a[100:103], v[68:71], v[40:43], a[100:103]
    v_mfma_f32_16x16x32_bf16 a[104:107], v[72:75], v[40:43], a[104:107]
    v_mfma_f32_16x16x32_bf16 a[108:111], v[76:79], v[40:43], a[108:111]
    ds_read_b128 v[40:43], v6 offset:40960
    s_waitcnt lgkmcnt(9)
    v_mfma_f32_16x16x32_bf16 a[112:115], v[64:67], v[44:47], a[112:115]
    ds_read_b64_tr_b16 v[120:121], v4 offset:32768
    v_mfma_f32_16x16x32_bf16 a[116:119], v[68:71], v[44:47], a[116:119]
    ds_read_b64_tr_b16 v[122:123], v4 offset:33280
    v_mfma_f32_16x16x32_bf16 a[120:123], v[72:75], v[44:47], a[120:123]
    v_mfma_f32_16x16x32_bf16 a[124:127], v[76:79], v[44:47], a[124:127]
    ds_read_b128 v[44:47], v6 offset:43008
    s_waitcnt lgkmcnt(11)
    v_mfma_f32_16x16x32_bf16 a[0:3], v[80:83], v[24:27], a[0:3]
    ds_read_b64_tr_b16 v[124:125], v5 offset:32768
    v_mfma_f32_16x16x32_bf16 a[4:7], v[84:87], v[24:27], a[4:7]
    ds_read_b64_tr_b16 v[126:127], v5 offset:33280
    v_mfma_f32_16x16x32_bf16 a[8:11], v[88:91], v[24:27], a[8:11]
    v_mfma_f32_16x16x32_bf16 a[12:15], v[92:95], v[24:27], a[12:15]
    ds_read_b128 v[24:27], v6 offset:45056
    s_waitcnt lgkmcnt(13)
    v_mfma_f32_16x16x32_bf16 a[16:19], v[80:83], v[28:31], a[16:19]
    v_mfma_f32_16x16x32_bf16 a[20:23], v[84:87], v[28:31], a[20:23]
    v_mfma_f32_16x16x32_bf16 a[24:27], v[88:91], v[28:31], a[24:27]
    v_mfma_f32_16x16x32_bf16 a[28:31], v[92:95], v[28:31], a[28:31]
    ds_read_b128 v[28:31], v6 offset:47104
    s_waitcnt lgkmcnt(12)
    v_mfma_f32_16x16x32_bf16 a[32:35], v[80:83], v[32:35], a[32:35]
    ds_read_b64_tr_b16 v[48:49], v2 offset:36864
    v_mfma_f32_16x16x32_bf16 a[36:39], v[84:87], v[32:35], a[36:39]
    ds_read_b64_tr_b16 v[50:51], v2 offset:37376
    v_mfma_f32_16x16x32_bf16 a[40:43], v[88:91], v[32:35], a[40:43]
    v_mfma_f32_16x16x32_bf16 a[44:47], v[92:95], v[32:35], a[44:47]
    ds_read_b128 v[32:35], v7 offset:32768
    s_waitcnt lgkmcnt(12)
    v_mfma_f32_16x16x32_bf16 a[48:51], v[80:83], v[36:39], a[48:51]
    ds_read_b64_tr_b16 v[52:53], v3 offset:36864
    v_mfma_f32_16x16x32_bf16 a[52:55], v[84:87], v[36:39], a[52:55]
    ds_read_b64_tr_b16 v[54:55], v3 offset:37376
    v_mfma_f32_16x16x32_bf16 a[56:59], v[88:91], v[36:39], a[56:59]
    v_mfma_f32_16x16x32_bf16 a[60:63], v[92:95], v[36:39], a[60:63]
    ds_read_b128 v[36:39], v7 offset:34816
    s_waitcnt lgkmcnt(13)
    v_mfma_f32_16x16x32_bf16 a[64:67], v[80:83], v[40:43], a[64:67]
    ds_read_b64_tr_b16 v[56:57], v4 offset:36864
    v_mfma_f32_16x16x32_bf16 a[68:71], v[84:87], v[40:43], a[68:71]
    v_mfma_f32_16x16x32_bf16 a[72:75], v[88:91], v[40:43], a[72:75]
    v_mfma_f32_16x16x32_bf16 a[76:79], v[92:95], v[40:43], a[76:79]
    ds_read_b128 v[40:43], v7 offset:36864
    s_waitcnt lgkmcnt(12)
    v_mfma_f32_16x16x32_bf16 a[80:83], v[80:83], v[44:47], a[80:83]
    ds_read_b64_tr_b16 v[58:59], v4 offset:37376
    v_mfma_f32_16x16x32_bf16 a[84:87], v[84:87], v[44:47], a[84:87]
    ds_read_b64_tr_b16 v[60:61], v5 offset:36864
    v_mfma_f32_16x16x32_bf16 a[88:91], v[88:91], v[44:47], a[88:91]
    v_mfma_f32_16x16x32_bf16 a[92:95], v[92:95], v[44:47], a[92:95]
    ds_read_b128 v[44:47], v7 offset:38912
    s_waitcnt lgkmcnt(12)
    v_mfma_f32_16x16x32_bf16 a[96:99], v[80:83], v[24:27], a[96:99]
    ds_read_b64_tr_b16 v[62:63], v5 offset:37376
    v_mfma_f32_16x16x32_bf16 a[100:103], v[84:87], v[24:27], a[100:103]
    v_mfma_f32_16x16x32_bf16 a[104:107], v[88:91], v[24:27], a[104:107]
    v_mfma_f32_16x16x32_bf16 a[108:111], v[92:95], v[24:27], a[108:111]
    ds_read_b128 v[24:27], v7 offset:40960
    s_waitcnt lgkmcnt(13)
    v_mfma_f32_16x16x32_bf16 a[112:115], v[80:83], v[28:31], a[112:115]
    v_mfma_f32_16x16x32_bf16 a[116:119], v[84:87], v[28:31], a[116:119]
    v_mfma_f32_16x16x32_bf16 a[120:123], v[88:91], v[28:31], a[120:123]
    v_mfma_f32_16x16x32_bf16 a[124:127], v[92:95], v[28:31], a[124:127]
    ds_read_b128 v[28:31], v7 offset:43008
    s_waitcnt lgkmcnt(11)
    v_mfma_f32_16x16x32_bf16 a[0:3], v[96:99], v[32:35], a[0:3]
    v_mfma_f32_16x16x32_bf16 a[4:7], v[100:103], v[32:35], a[4:7]
    v_mfma_f32_16x16x32_bf16 a[8:11], v[104:107], v[32:35], a[8:11]
    v_mfma_f32_16x16x32_bf16 a[12:15], v[108:111], v[32:35], a[12:15]
    ds_read_b128 v[32:35], v7 offset:45056
    s_waitcnt lgkmcnt(9)
    v_mfma_f32_16x16x32_bf16 a[16:19], v[96:99], v[36:39], a[16:19]
    v_mfma_f32_16x16x32_bf16 a[20:23], v[100:103], v[36:39], a[20:23]
    v_mfma_f32_16x16x32_bf16 a[24:27], v[104:107], v[36:39], a[24:27]
    v_mfma_f32_16x16x32_bf16 a[28:31], v[108:111], v[36:39], a[28:31]
    ds_read_b128 v[36:39], v7 offset:47104
    s_waitcnt lgkmcnt(8)
    v_mfma_f32_16x16x32_bf16 a[32:35], v[96:99], v[40:43], a[32:35]
    v_mfma_f32_16x16x32_bf16 a[36:39], v[100:103], v[40:43], a[36:39]
    v_mfma_f32_16x16x32_bf16 a[40:43], v[104:107], v[40:43], a[40:43]
    v_mfma_f32_16x16x32_bf16 a[44:47], v[108:111], v[40:43], a[44:47]
    s_waitcnt lgkmcnt(4)
    s_barrier
    ds_read_b128 v[40:43], v6 offset:49152
    v_mfma_f32_16x16x32_bf16 a[48:51], v[96:99], v[44:47], a[48:51]
    v_mfma_f32_16x16x32_bf16 a[52:55], v[100:103], v[44:47], a[52:55]
    v_mfma_f32_16x16x32_bf16 a[56:59], v[104:107], v[44:47], a[56:59]
    v_mfma_f32_16x16x32_bf16 a[60:63], v[108:111], v[44:47], a[60:63]
    ds_read_b128 v[44:47], v6 offset:51200
    s_waitcnt lgkmcnt(5)
    v_mfma_f32_16x16x32_bf16 a[64:67], v[96:99], v[24:27], a[64:67]
    v_add_u32 v2, 32768, v2
    v_add_u32 v3, 32768, v3
    v_add_u32 v4, 32768, v4
    v_add_u32 v5, 32768, v5
    v_mfma_f32_16x16x32_bf16 a[68:71], v[100:103], v[24:27], a[68:71]
    ds_read_b64_tr_b16 v[64:65], v2 offset:32768
    v_mfma_f32_16x16x32_bf16 a[72:75], v[104:107], v[24:27], a[72:75]
    v_mfma_f32_16x16x32_bf16 a[76:79], v[108:111], v[24:27], a[76:79]
    ds_read_b128 v[24:27], v6 offset:53248
    s_waitcnt lgkmcnt(6)
    v_mfma_f32_16x16x32_bf16 a[80:83], v[96:99], v[28:31], a[80:83]
    ds_read_b64_tr_b16 v[66:67], v2 offset:33280
    v_mfma_f32_16x16x32_bf16 a[84:87], v[100:103], v[28:31], a[84:87]
    ds_read_b64_tr_b16 v[68:69], v3 offset:32768
    v_mfma_f32_16x16x32_bf16 a[88:91], v[104:107], v[28:31], a[88:91]
    v_mfma_f32_16x16x32_bf16 a[92:95], v[108:111], v[28:31], a[92:95]
    ds_read_b128 v[28:31], v6 offset:55296
    s_waitcnt lgkmcnt(8)
    v_mfma_f32_16x16x32_bf16 a[96:99], v[96:99], v[32:35], a[96:99]
    ds_read_b64_tr_b16 v[70:71], v3 offset:33280
    v_mfma_f32_16x16x32_bf16 a[100:103], v[100:103], v[32:35], a[100:103]
    v_mfma_f32_16x16x32_bf16 a[104:107], v[104:107], v[32:35], a[104:107]
    v_mfma_f32_16x16x32_bf16 a[108:111], v[108:111], v[32:35], a[108:111]
    ds_read_b128 v[32:35], v6 offset:57344
    s_waitcnt lgkmcnt(9)
    v_mfma_f32_16x16x32_bf16 a[112:115], v[96:99], v[36:39], a[112:115]
    ds_read_b64_tr_b16 v[72:73], v4 offset:32768
    v_mfma_f32_16x16x32_bf16 a[116:119], v[100:103], v[36:39], a[116:119]
    ds_read_b64_tr_b16 v[74:75], v4 offset:33280
    v_mfma_f32_16x16x32_bf16 a[120:123], v[104:107], v[36:39], a[120:123]
    v_mfma_f32_16x16x32_bf16 a[124:127], v[108:111], v[36:39], a[124:127]
    ds_read_b128 v[36:39], v6 offset:59392
    s_waitcnt lgkmcnt(11)
    v_mfma_f32_16x16x32_bf16 a[0:3], v[112:115], v[40:43], a[0:3]
    ds_read_b64_tr_b16 v[76:77], v5 offset:32768
    v_mfma_f32_16x16x32_bf16 a[4:7], v[116:119], v[40:43], a[4:7]
    ds_read_b64_tr_b16 v[78:79], v5 offset:33280
    v_mfma_f32_16x16x32_bf16 a[8:11], v[120:123], v[40:43], a[8:11]
    v_mfma_f32_16x16x32_bf16 a[12:15], v[124:127], v[40:43], a[12:15]
    ds_read_b128 v[40:43], v6 offset:61440
    s_waitcnt lgkmcnt(13)
    v_mfma_f32_16x16x32_bf16 a[16:19], v[112:115], v[44:47], a[16:19]
    v_mfma_f32_16x16x32_bf16 a[20:23], v[116:119], v[44:47], a[20:23]
    v_mfma_f32_16x16x32_bf16 a[24:27], v[120:123], v[44:47], a[24:27]
    v_mfma_f32_16x16x32_bf16 a[28:31], v[124:127], v[44:47], a[28:31]
    ds_read_b128 v[44:47], v6 offset:63488
    s_waitcnt lgkmcnt(12)
    v_mfma_f32_16x16x32_bf16 a[32:35], v[112:115], v[24:27], a[32:35]
    ds_read_b64_tr_b16 v[80:81], v2 offset:36864
    v_mfma_f32_16x16x32_bf16 a[36:39], v[116:119], v[24:27], a[36:39]
    ds_read_b64_tr_b16 v[82:83], v2 offset:37376
    v_mfma_f32_16x16x32_bf16 a[40:43], v[120:123], v[24:27], a[40:43]
    v_mfma_f32_16x16x32_bf16 a[44:47], v[124:127], v[24:27], a[44:47]
    ds_read_b128 v[24:27], v7 offset:49152
    s_waitcnt lgkmcnt(12)
    v_mfma_f32_16x16x32_bf16 a[48:51], v[112:115], v[28:31], a[48:51]
    ds_read_b64_tr_b16 v[84:85], v3 offset:36864
    v_mfma_f32_16x16x32_bf16 a[52:55], v[116:119], v[28:31], a[52:55]
    ds_read_b64_tr_b16 v[86:87], v3 offset:37376
    v_mfma_f32_16x16x32_bf16 a[56:59], v[120:123], v[28:31], a[56:59]
    v_mfma_f32_16x16x32_bf16 a[60:63], v[124:127], v[28:31], a[60:63]
    ds_read_b128 v[28:31], v7 offset:51200
    s_waitcnt lgkmcnt(13)
    v_mfma_f32_16x16x32_bf16 a[64:67], v[112:115], v[32:35], a[64:67]
    ds_read_b64_tr_b16 v[88:89], v4 offset:36864
    v_mfma_f32_16x16x32_bf16 a[68:71], v[116:119], v[32:35], a[68:71]
    v_mfma_f32_16x16x32_bf16 a[72:75], v[120:123], v[32:35], a[72:75]
    v_mfma_f32_16x16x32_bf16 a[76:79], v[124:127], v[32:35], a[76:79]
    ds_read_b128 v[32:35], v7 offset:53248
    s_waitcnt lgkmcnt(12)
    v_mfma_f32_16x16x32_bf16 a[80:83], v[112:115], v[36:39], a[80:83]
    ds_read_b64_tr_b16 v[90:91], v4 offset:37376
    v_mfma_f32_16x16x32_bf16 a[84:87], v[116:119], v[36:39], a[84:87]
    ds_read_b64_tr_b16 v[92:93], v5 offset:36864
    v_mfma_f32_16x16x32_bf16 a[88:91], v[120:123], v[36:39], a[88:91]
    v_mfma_f32_16x16x32_bf16 a[92:95], v[124:127], v[36:39], a[92:95]
    ds_read_b128 v[36:39], v7 offset:55296
    s_waitcnt lgkmcnt(12)
    v_mfma_f32_16x16x32_bf16 a[96:99], v[112:115], v[40:43], a[96:99]
    ds_read_b64_tr_b16 v[94:95], v5 offset:37376
    v_mfma_f32_16x16x32_bf16 a[100:103], v[116:119], v[40:43], a[100:103]
    v_mfma_f32_16x16x32_bf16 a[104:107], v[120:123], v[40:43], a[104:107]
    v_mfma_f32_16x16x32_bf16 a[108:111], v[124:127], v[40:43], a[108:111]
    ds_read_b128 v[40:43], v7 offset:57344
    s_waitcnt lgkmcnt(13)
    v_mfma_f32_16x16x32_bf16 a[112:115], v[112:115], v[44:47], a[112:115]
    v_mfma_f32_16x16x32_bf16 a[116:119], v[116:119], v[44:47], a[116:119]
    v_mfma_f32_16x16x32_bf16 a[120:123], v[120:123], v[44:47], a[120:123]
    v_mfma_f32_16x16x32_bf16 a[124:127], v[124:127], v[44:47], a[124:127]
    ds_read_b128 v[44:47], v7 offset:59392
    s_waitcnt lgkmcnt(11)
    v_mfma_f32_16x16x32_bf16 a[0:3], v[48:51], v[24:27], a[0:3]
    v_mfma_f32_16x16x32_bf16 a[4:7], v[52:55], v[24:27], a[4:7]
    v_mfma_f32_16x16x32_bf16 a[8:11], v[56:59], v[24:27], a[8:11]
    v_mfma_f32_16x16x32_bf16 a[12:15], v[60:63], v[24:27], a[12:15]
    ds_read_b128 v[24:27], v7 offset:61440
    s_waitcnt lgkmcnt(9)
    v_mfma_f32_16x16x32_bf16 a[16:19], v[48:51], v[28:31], a[16:19]
    v_mfma_f32_16x16x32_bf16 a[20:23], v[52:55], v[28:31], a[20:23]
    v_mfma_f32_16x16x32_bf16 a[24:27], v[56:59], v[28:31], a[24:27]
    v_mfma_f32_16x16x32_bf16 a[28:31], v[60:63], v[28:31], a[28:31]
    ds_read_b128 v[28:31], v7 offset:63488
    s_waitcnt lgkmcnt(8)
    v_mfma_f32_16x16x32_bf16 a[32:35], v[48:51], v[32:35], a[32:35]
    v_mfma_f32_16x16x32_bf16 a[36:39], v[52:55], v[32:35], a[36:39]
    v_mfma_f32_16x16x32_bf16 a[40:43], v[56:59], v[32:35], a[40:43]
    v_mfma_f32_16x16x32_bf16 a[44:47], v[60:63], v[32:35], a[44:47]
    s_waitcnt lgkmcnt(4)
    s_barrier
    ds_read_b128 v[32:35], v6 offset:0
    v_mfma_f32_16x16x32_bf16 a[48:51], v[48:51], v[36:39], a[48:51]
    v_mfma_f32_16x16x32_bf16 a[52:55], v[52:55], v[36:39], a[52:55]
    v_mfma_f32_16x16x32_bf16 a[56:59], v[56:59], v[36:39], a[56:59]
    v_mfma_f32_16x16x32_bf16 a[60:63], v[60:63], v[36:39], a[60:63]
    ds_read_b128 v[36:39], v6 offset:2048
    s_waitcnt lgkmcnt(5)
    v_mfma_f32_16x16x32_bf16 a[64:67], v[48:51], v[40:43], a[64:67]
    v_add_u32 v2, 4294934528, v2
    v_add_u32 v3, 4294934528, v3
    v_add_u32 v4, 4294934528, v4
    v_add_u32 v5, 4294934528, v5
    v_mfma_f32_16x16x32_bf16 a[68:71], v[52:55], v[40:43], a[68:71]
    ds_read_b64_tr_b16 v[96:97], v2 offset:0
    v_mfma_f32_16x16x32_bf16 a[72:75], v[56:59], v[40:43], a[72:75]
    v_mfma_f32_16x16x32_bf16 a[76:79], v[60:63], v[40:43], a[76:79]
    ds_read_b128 v[40:43], v6 offset:4096
    s_waitcnt lgkmcnt(6)
    v_mfma_f32_16x16x32_bf16 a[80:83], v[48:51], v[44:47], a[80:83]
    ds_read_b64_tr_b16 v[98:99], v2 offset:512
    v_mfma_f32_16x16x32_bf16 a[84:87], v[52:55], v[44:47], a[84:87]
    ds_read_b64_tr_b16 v[100:101], v3 offset:0
    v_mfma_f32_16x16x32_bf16 a[88:91], v[56:59], v[44:47], a[88:91]
    v_mfma_f32_16x16x32_bf16 a[92:95], v[60:63], v[44:47], a[92:95]
    ds_read_b128 v[44:47], v6 offset:6144
    s_waitcnt lgkmcnt(8)
    v_mfma_f32_16x16x32_bf16 a[96:99], v[48:51], v[24:27], a[96:99]
    ds_read_b64_tr_b16 v[102:103], v3 offset:512
    v_mfma_f32_16x16x32_bf16 a[100:103], v[52:55], v[24:27], a[100:103]
    v_mfma_f32_16x16x32_bf16 a[104:107], v[56:59], v[24:27], a[104:107]
    v_mfma_f32_16x16x32_bf16 a[108:111], v[60:63], v[24:27], a[108:111]
    ds_read_b128 v[24:27], v6 offset:8192
    s_waitcnt lgkmcnt(9)
    v_mfma_f32_16x16x32_bf16 a[112:115], v[48:51], v[28:31], a[112:115]
    ds_read_b64_tr_b16 v[104:105], v4 offset:0
    v_mfma_f32_16x16x32_bf16 a[116:119], v[52:55], v[28:31], a[116:119]
    ds_read_b64_tr_b16 v[106:107], v4 offset:512
    v_mfma_f32_16x16x32_bf16 a[120:123], v[56:59], v[28:31], a[120:123]
    v_mfma_f32_16x16x32_bf16 a[124:127], v[60:63], v[28:31], a[124:127]
    ds_read_b128 v[28:31], v6 offset:10240
    s_waitcnt lgkmcnt(11)
    v_mfma_f32_16x16x32_bf16 a[0:3], v[64:67], v[32:35], a[0:3]
    ds_read_b64_tr_b16 v[108:109], v5 offset:0
    v_mfma_f32_16x16x32_bf16 a[4:7], v[68:71], v[32:35], a[4:7]
    ds_read_b64_tr_b16 v[110:111], v5 offset:512
    v_mfma_f32_16x16x32_bf16 a[8:11], v[72:75], v[32:35], a[8:11]
    v_mfma_f32_16x16x32_bf16 a[12:15], v[76:79], v[32:35], a[12:15]
    ds_read_b128 v[32:35], v6 offset:12288
    s_waitcnt lgkmcnt(13)
    v_mfma_f32_16x16x32_bf16 a[16:19], v[64:67], v[36:39], a[16:19]
    v_mfma_f32_16x16x32_bf16 a[20:23], v[68:71], v[36:39], a[20:23]
    v_mfma_f32_16x16x32_bf16 a[24:27], v[72:75], v[36:39], a[24:27]
    v_mfma_f32_16x16x32_bf16 a[28:31], v[76:79], v[36:39], a[28:31]
    ds_read_b128 v[36:39], v6 offset:14336
    s_waitcnt lgkmcnt(12)
    v_mfma_f32_16x16x32_bf16 a[32:35], v[64:67], v[40:43], a[32:35]
    ds_read_b64_tr_b16 v[112:113], v2 offset:4096
    v_mfma_f32_16x16x32_bf16 a[36:39], v[68:71], v[40:43], a[36:39]
    ds_read_b64_tr_b16 v[114:115], v2 offset:4608
    v_mfma_f32_16x16x32_bf16 a[40:43], v[72:75], v[40:43], a[40:43]
    v_mfma_f32_16x16x32_bf16 a[44:47], v[76:79], v[40:43], a[44:47]
    ds_read_b128 v[40:43], v7 offset:0
    s_waitcnt lgkmcnt(12)
    v_mfma_f32_16x16x32_bf16 a[48:51], v[64:67], v[44:47], a[48:51]
    ds_read_b64_tr_b16 v[116:117], v3 offset:4096
    v_mfma_f32_16x16x32_bf16 a[52:55], v[68:71], v[44:47], a[52:55]
    ds_read_b64_tr_b16 v[118:119], v3 offset:4608
    v_mfma_f32_16x16x32_bf16 a[56:59], v[72:75], v[44:47], a[56:59]
    v_mfma_f32_16x16x32_bf16 a[60:63], v[76:79], v[44:47], a[60:63]
    ds_read_b128 v[44:47], v7 offset:2048
    s_waitcnt lgkmcnt(13)
    v_mfma_f32_16x16x32_bf16 a[64:67], v[64:67], v[24:27], a[64:67]
    ds_read_b64_tr_b16 v[120:121], v4 offset:4096
    v_mfma_f32_16x16x32_bf16 a[68:71], v[68:71], v[24:27], a[68:71]
    v_mfma_f32_16x16x32_bf16 a[72:75], v[72:75], v[24:27], a[72:75]
    v_mfma_f32_16x16x32_bf16 a[76:79], v[76:79], v[24:27], a[76:79]
    ds_read_b128 v[24:27], v7 offset:4096
    s_waitcnt lgkmcnt(12)
    v_mfma_f32_16x16x32_bf16 a[80:83], v[64:67], v[28:31], a[80:83]
    ds_read_b64_tr_b16 v[122:123], v4 offset:4608
    v_mfma_f32_16x16x32_bf16 a[84:87], v[68:71], v[28:31], a[84:87]
    ds_read_b64_tr_b16 v[124:125], v5 offset:4096
    v_mfma_f32_16x16x32_bf16 a[88:91], v[72:75], v[28:31], a[88:91]
    v_mfma_f32_16x16x32_bf16 a[92:95], v[76:79], v[28:31], a[92:95]
    ds_read_b128 v[28:31], v7 offset:6144
    s_waitcnt lgkmcnt(12)
    v_mfma_f32_16x16x32_bf16 a[96:99], v[64:67], v[32:35], a[96:99]
    ds_read_b64_tr_b16 v[126:127], v5 offset:4608
    v_mfma_f32_16x16x32_bf16 a[100:103], v[68:71], v[32:35], a[100:103]
    v_mfma_f32_16x16x32_bf16 a[104:107], v[72:75], v[32:35], a[104:107]
    v_mfma_f32_16x16x32_bf16 a[108:111], v[76:79], v[32:35], a[108:111]
    ds_read_b128 v[32:35], v7 offset:8192
    s_waitcnt lgkmcnt(13)
    v_mfma_f32_16x16x32_bf16 a[112:115], v[64:67], v[36:39], a[112:115]
    v_mfma_f32_16x16x32_bf16 a[116:119], v[68:71], v[36:39], a[116:119]
    v_mfma_f32_16x16x32_bf16 a[120:123], v[72:75], v[36:39], a[120:123]
    v_mfma_f32_16x16x32_bf16 a[124:127], v[76:79], v[36:39], a[124:127]
    ds_read_b128 v[36:39], v7 offset:10240
    s_waitcnt lgkmcnt(11)
    v_mfma_f32_16x16x32_bf16 a[0:3], v[80:83], v[40:43], a[0:3]
    buffer_load_dword v12, v10, s[60:63], s46 offen sc1
    v_mfma_f32_16x16x32_bf16 a[4:7], v[84:87], v[40:43], a[4:7]
    v_mfma_f32_16x16x32_bf16 a[8:11], v[88:91], v[40:43], a[8:11]
    v_mfma_f32_16x16x32_bf16 a[12:15], v[92:95], v[40:43], a[12:15]
    ds_read_b128 v[40:43], v7 offset:12288
    s_waitcnt lgkmcnt(9)
    v_mfma_f32_16x16x32_bf16 a[16:19], v[80:83], v[44:47], a[16:19]
    v_mfma_f32_16x16x32_bf16 a[20:23], v[84:87], v[44:47], a[20:23]
    v_mfma_f32_16x16x32_bf16 a[24:27], v[88:91], v[44:47], a[24:27]
    v_mfma_f32_16x16x32_bf16 a[28:31], v[92:95], v[44:47], a[28:31]
    ds_read_b128 v[44:47], v7 offset:14336
    s_waitcnt lgkmcnt(8)
    v_mfma_f32_16x16x32_bf16 a[32:35], v[80:83], v[24:27], a[32:35]
    v_mfma_f32_16x16x32_bf16 a[36:39], v[84:87], v[24:27], a[36:39]
    v_mfma_f32_16x16x32_bf16 a[40:43], v[88:91], v[24:27], a[40:43]
    v_mfma_f32_16x16x32_bf16 a[44:47], v[92:95], v[24:27], a[44:47]
    s_waitcnt lgkmcnt(4)
    s_barrier
    ds_read_b128 v[24:27], v6 offset:16384
    v_mfma_f32_16x16x32_bf16 a[48:51], v[80:83], v[28:31], a[48:51]
    v_mfma_f32_16x16x32_bf16 a[52:55], v[84:87], v[28:31], a[52:55]
    v_mfma_f32_16x16x32_bf16 a[56:59], v[88:91], v[28:31], a[56:59]
    v_mfma_f32_16x16x32_bf16 a[60:63], v[92:95], v[28:31], a[60:63]
    ds_read_b128 v[28:31], v6 offset:18432
    s_waitcnt lgkmcnt(5)
    v_mfma_f32_16x16x32_bf16 a[64:67], v[80:83], v[32:35], a[64:67]
    v_mfma_f32_16x16x32_bf16 a[68:71], v[84:87], v[32:35], a[68:71]
    ds_read_b64_tr_b16 v[48:49], v2 offset:32768
    v_mfma_f32_16x16x32_bf16 a[72:75], v[88:91], v[32:35], a[72:75]
    v_mfma_f32_16x16x32_bf16 a[76:79], v[92:95], v[32:35], a[76:79]
    ds_read_b128 v[32:35], v6 offset:20480
    s_waitcnt lgkmcnt(6)
    v_mfma_f32_16x16x32_bf16 a[80:83], v[80:83], v[36:39], a[80:83]
    ds_read_b64_tr_b16 v[50:51], v2 offset:33280
    v_mfma_f32_16x16x32_bf16 a[84:87], v[84:87], v[36:39], a[84:87]
    ds_read_b64_tr_b16 v[52:53], v3 offset:32768
    v_mfma_f32_16x16x32_bf16 a[88:91], v[88:91], v[36:39], a[88:91]
    v_mfma_f32_16x16x32_bf16 a[92:95], v[92:95], v[36:39], a[92:95]
    ds_read_b128 v[36:39], v6 offset:22528
    s_waitcnt lgkmcnt(8)
    v_mfma_f32_16x16x32_bf16 a[96:99], v[80:83], v[40:43], a[96:99]
    ds_read_b64_tr_b16 v[54:55], v3 offset:33280
    v_mfma_f32_16x16x32_bf16 a[100:103], v[84:87], v[40:43], a[100:103]
    v_mfma_f32_16x16x32_bf16 a[104:107], v[88:91], v[40:43], a[104:107]
    v_mfma_f32_16x16x32_bf16 a[108:111], v[92:95], v[40:43], a[108:111]
    ds_read_b128 v[40:43], v6 offset:24576
    s_waitcnt lgkmcnt(9)
    v_mfma_f32_16x16x32_bf16 a[112:115], v[80:83], v[44:47], a[112:115]
    ds_read_b64_tr_b16 v[56:57], v4 offset:32768
    v_mfma_f32_16x16x32_bf16 a[116:119], v[84:87], v[44:47], a[116:119]
    ds_read_b64_tr_b16 v[58:59], v4 offset:33280
    v_mfma_f32_16x16x32_bf16 a[120:123], v[88:91], v[44:47], a[120:123]
    v_mfma_f32_16x16x32_bf16 a[124:127], v[92:95], v[44:47], a[124:127]
    ds_read_b128 v[44:47], v6 offset:26624
    s_waitcnt lgkmcnt(11)
    v_mfma_f32_16x16x32_bf16 a[0:3], v[96:99], v[24:27], a[0:3]
    ds_read_b64_tr_b16 v[60:61], v5 offset:32768
    v_mfma_f32_16x16x32_bf16 a[4:7], v[100:103], v[24:27], a[4:7]
    ds_read_b64_tr_b16 v[62:63], v5 offset:33280
    v_mfma_f32_16x16x32_bf16 a[8:11], v[104:107], v[24:27], a[8:11]
    v_mfma_f32_16x16x32_bf16 a[12:15], v[108:111], v[24:27], a[12:15]
    ds_read_b128 v[24:27], v6 offset:28672
    s_waitcnt lgkmcnt(13)
    v_mfma_f32_16x16x32_bf16 a[16:19], v[96:99], v[28:31], a[16:19]
    v_mfma_f32_16x16x32_bf16 a[20:23], v[100:103], v[28:31], a[20:23]
    v_mfma_f32_16x16x32_bf16 a[24:27], v[104:107], v[28:31], a[24:27]
    v_mfma_f32_16x16x32_bf16 a[28:31], v[108:111], v[28:31], a[28:31]
    ds_read_b128 v[28:31], v6 offset:30720
    s_waitcnt lgkmcnt(12)
    v_mfma_f32_16x16x32_bf16 a[32:35], v[96:99], v[32:35], a[32:35]
    ds_read_b64_tr_b16 v[64:65], v2 offset:36864
    v_mfma_f32_16x16x32_bf16 a[36:39], v[100:103], v[32:35], a[36:39]
    ds_read_b64_tr_b16 v[66:67], v2 offset:37376
    v_mfma_f32_16x16x32_bf16 a[40:43], v[104:107], v[32:35], a[40:43]
    v_mfma_f32_16x16x32_bf16 a[44:47], v[108:111], v[32:35], a[44:47]
    ds_read_b128 v[32:35], v7 offset:16384
    s_waitcnt lgkmcnt(12)
    v_mfma_f32_16x16x32_bf16 a[48:51], v[96:99], v[36:39], a[48:51]
    ds_read_b64_tr_b16 v[68:69], v3 offset:36864
    v_mfma_f32_16x16x32_bf16 a[52:55], v[100:103], v[36:39], a[52:55]
    ds_read_b64_tr_b16 v[70:71], v3 offset:37376
    v_mfma_f32_16x16x32_bf16 a[56:59], v[104:107], v[36:39], a[56:59]
    v_mfma_f32_16x16x32_bf16 a[60:63], v[108:111], v[36:39], a[60:63]
    ds_read_b128 v[36:39], v7 offset:18432
    s_waitcnt lgkmcnt(13)
    v_mfma_f32_16x16x32_bf16 a[64:67], v[96:99], v[40:43], a[64:67]
    ds_read_b64_tr_b16 v[72:73], v4 offset:36864
    v_mfma_f32_16x16x32_bf16 a[68:71], v[100:103], v[40:43], a[68:71]
    v_mfma_f32_16x16x32_bf16 a[72:75], v[104:107], v[40:43], a[72:75]
    v_mfma_f32_16x16x32_bf16 a[76:79], v[108:111], v[40:43], a[76:79]
    ds_read_b128 v[40:43], v7 offset:20480
    s_waitcnt lgkmcnt(12)
    v_mfma_f32_16x16x32_bf16 a[80:83], v[96:99], v[44:47], a[80:83]
    ds_read_b64_tr_b16 v[74:75], v4 offset:37376
    v_mfma_f32_16x16x32_bf16 a[84:87], v[100:103], v[44:47], a[84:87]
    ds_read_b64_tr_b16 v[76:77], v5 offset:36864
    v_mfma_f32_16x16x32_bf16 a[88:91], v[104:107], v[44:47], a[88:91]
    v_mfma_f32_16x16x32_bf16 a[92:95], v[108:111], v[44:47], a[92:95]
    ds_read_b128 v[44:47], v7 offset:22528
    s_waitcnt lgkmcnt(12)
    v_mfma_f32_16x16x32_bf16 a[96:99], v[96:99], v[24:27], a[96:99]
    ds_read_b64_tr_b16 v[78:79], v5 offset:37376
    v_mfma_f32_16x16x32_bf16 a[100:103], v[100:103], v[24:27], a[100:103]
    v_mfma_f32_16x16x32_bf16 a[104:107], v[104:107], v[24:27], a[104:107]
    v_mfma_f32_16x16x32_bf16 a[108:111], v[108:111], v[24:27], a[108:111]
    ds_read_b128 v[24:27], v7 offset:24576
    s_waitcnt lgkmcnt(13)
    v_mfma_f32_16x16x32_bf16 a[112:115], v[96:99], v[28:31], a[112:115]
    v_mfma_f32_16x16x32_bf16 a[116:119], v[100:103], v[28:31], a[116:119]
    v_mfma_f32_16x16x32_bf16 a[120:123], v[104:107], v[28:31], a[120:123]
    v_mfma_f32_16x16x32_bf16 a[124:127], v[108:111], v[28:31], a[124:127]
    ds_read_b128 v[28:31], v7 offset:26624
    s_waitcnt lgkmcnt(11)
    v_mfma_f32_16x16x32_bf16 a[0:3], v[112:115], v[32:35], a[0:3]
    v_mfma_f32_16x16x32_bf16 a[4:7], v[116:119], v[32:35], a[4:7]
    v_mfma_f32_16x16x32_bf16 a[8:11], v[120:123], v[32:35], a[8:11]
    v_mfma_f32_16x16x32_bf16 a[12:15], v[124:127], v[32:35], a[12:15]
    ds_read_b128 v[32:35], v7 offset:28672
    s_waitcnt lgkmcnt(9)
    v_mfma_f32_16x16x32_bf16 a[16:19], v[112:115], v[36:39], a[16:19]
    v_mfma_f32_16x16x32_bf16 a[20:23], v[116:119], v[36:39], a[20:23]
    v_mfma_f32_16x16x32_bf16 a[24:27], v[120:123], v[36:39], a[24:27]
    v_mfma_f32_16x16x32_bf16 a[28:31], v[124:127], v[36:39], a[28:31]
    ds_read_b128 v[36:39], v7 offset:30720
    s_waitcnt lgkmcnt(8)
    v_mfma_f32_16x16x32_bf16 a[32:35], v[112:115], v[40:43], a[32:35]
    v_mfma_f32_16x16x32_bf16 a[36:39], v[116:119], v[40:43], a[36:39]
    v_mfma_f32_16x16x32_bf16 a[40:43], v[120:123], v[40:43], a[40:43]
    v_mfma_f32_16x16x32_bf16 a[44:47], v[124:127], v[40:43], a[44:47]
    s_waitcnt lgkmcnt(4)
    s_barrier
    ds_read_b128 v[40:43], v6 offset:32768
    v_mfma_f32_16x16x32_bf16 a[48:51], v[112:115], v[44:47], a[48:51]
    v_mfma_f32_16x16x32_bf16 a[52:55], v[116:119], v[44:47], a[52:55]
    v_mfma_f32_16x16x32_bf16 a[56:59], v[120:123], v[44:47], a[56:59]
    v_mfma_f32_16x16x32_bf16 a[60:63], v[124:127], v[44:47], a[60:63]
    ds_read_b128 v[44:47], v6 offset:34816
    s_waitcnt lgkmcnt(5)
    v_mfma_f32_16x16x32_bf16 a[64:67], v[112:115], v[24:27], a[64:67]
    v_add_u32 v2, 32768, v2
    v_add_u32 v3, 32768, v3
    v_add_u32 v4, 32768, v4
    v_add_u32 v5, 32768, v5
    v_mfma_f32_16x16x32_bf16 a[68:71], v[116:119], v[24:27], a[68:71]
    ds_read_b64_tr_b16 v[80:81], v2 offset:32768
    v_mfma_f32_16x16x32_bf16 a[72:75], v[120:123], v[24:27], a[72:75]
    v_mfma_f32_16x16x32_bf16 a[76:79], v[124:127], v[24:27], a[76:79]
    ds_read_b128 v[24:27], v6 offset:36864
    s_waitcnt lgkmcnt(6)
    v_mfma_f32_16x16x32_bf16 a[80:83], v[112:115], v[28:31], a[80:83]
    ds_read_b64_tr_b16 v[82:83], v2 offset:33280
    v_mfma_f32_16x16x32_bf16 a[84:87], v[116:119], v[28:31], a[84:87]
    ds_read_b64_tr_b16 v[84:85], v3 offset:32768
    v_mfma_f32_16x16x32_bf16 a[88:91], v[120:123], v[28:31], a[88:91]
    v_mfma_f32_16x16x32_bf16 a[92:95], v[124:127], v[28:31], a[92:95]
    ds_read_b128 v[28:31], v6 offset:38912
    s_waitcnt lgkmcnt(8)
    v_mfma_f32_16x16x32_bf16 a[96:99], v[112:115], v[32:35], a[96:99]
    ds_read_b64_tr_b16 v[86:87], v3 offset:33280
    v_mfma_f32_16x16x32_bf16 a[100:103], v[116:119], v[32:35], a[100:103]
    v_mfma_f32_16x16x32_bf16 a[104:107], v[120:123], v[32:35], a[104:107]
    v_mfma_f32_16x16x32_bf16 a[108:111], v[124:127], v[32:35], a[108:111]
    ds_read_b128 v[32:35], v6 offset:40960
    s_waitcnt lgkmcnt(9)
    v_mfma_f32_16x16x32_bf16 a[112:115], v[112:115], v[36:39], a[112:115]
    ds_read_b64_tr_b16 v[88:89], v4 offset:32768
    v_mfma_f32_16x16x32_bf16 a[116:119], v[116:119], v[36:39], a[116:119]
    ds_read_b64_tr_b16 v[90:91], v4 offset:33280
    v_mfma_f32_16x16x32_bf16 a[120:123], v[120:123], v[36:39], a[120:123]
    v_mfma_f32_16x16x32_bf16 a[124:127], v[124:127], v[36:39], a[124:127]
    ds_read_b128 v[36:39], v6 offset:43008
    s_waitcnt lgkmcnt(11)
    v_mfma_f32_16x16x32_bf16 a[0:3], v[48:51], v[40:43], a[0:3]
    ds_read_b64_tr_b16 v[92:93], v5 offset:32768
    v_mfma_f32_16x16x32_bf16 a[4:7], v[52:55], v[40:43], a[4:7]
    ds_read_b64_tr_b16 v[94:95], v5 offset:33280
    v_mfma_f32_16x16x32_bf16 a[8:11], v[56:59], v[40:43], a[8:11]
    v_mfma_f32_16x16x32_bf16 a[12:15], v[60:63], v[40:43], a[12:15]
    ds_read_b128 v[40:43], v6 offset:45056
    s_waitcnt lgkmcnt(13)
    v_mfma_f32_16x16x32_bf16 a[16:19], v[48:51], v[44:47], a[16:19]
    v_mfma_f32_16x16x32_bf16 a[20:23], v[52:55], v[44:47], a[20:23]
    v_mfma_f32_16x16x32_bf16 a[24:27], v[56:59], v[44:47], a[24:27]
    v_mfma_f32_16x16x32_bf16 a[28:31], v[60:63], v[44:47], a[28:31]
    ds_read_b128 v[44:47], v6 offset:47104
    s_waitcnt lgkmcnt(12)
    v_mfma_f32_16x16x32_bf16 a[32:35], v[48:51], v[24:27], a[32:35]
    ds_read_b64_tr_b16 v[96:97], v2 offset:36864
    v_mfma_f32_16x16x32_bf16 a[36:39], v[52:55], v[24:27], a[36:39]
    ds_read_b64_tr_b16 v[98:99], v2 offset:37376
    v_mfma_f32_16x16x32_bf16 a[40:43], v[56:59], v[24:27], a[40:43]
    v_mfma_f32_16x16x32_bf16 a[44:47], v[60:63], v[24:27], a[44:47]
    ds_read_b128 v[24:27], v7 offset:32768
    s_waitcnt lgkmcnt(12)
    v_mfma_f32_16x16x32_bf16 a[48:51], v[48:51], v[28:31], a[48:51]
    ds_read_b64_tr_b16 v[100:101], v3 offset:36864
    v_mfma_f32_16x16x32_bf16 a[52:55], v[52:55], v[28:31], a[52:55]
    ds_read_b64_tr_b16 v[102:103], v3 offset:37376
    v_mfma_f32_16x16x32_bf16 a[56:59], v[56:59], v[28:31], a[56:59]
    v_mfma_f32_16x16x32_bf16 a[60:63], v[60:63], v[28:31], a[60:63]
    ds_read_b128 v[28:31], v7 offset:34816
    s_waitcnt lgkmcnt(13)
    v_mfma_f32_16x16x32_bf16 a[64:67], v[48:51], v[32:35], a[64:67]
    ds_read_b64_tr_b16 v[104:105], v4 offset:36864
    v_mfma_f32_16x16x32_bf16 a[68:71], v[52:55], v[32:35], a[68:71]
    v_mfma_f32_16x16x32_bf16 a[72:75], v[56:59], v[32:35], a[72:75]
    v_mfma_f32_16x16x32_bf16 a[76:79], v[60:63], v[32:35], a[76:79]
    ds_read_b128 v[32:35], v7 offset:36864
    s_waitcnt lgkmcnt(12)
    v_mfma_f32_16x16x32_bf16 a[80:83], v[48:51], v[36:39], a[80:83]
    ds_read_b64_tr_b16 v[106:107], v4 offset:37376
    v_mfma_f32_16x16x32_bf16 a[84:87], v[52:55], v[36:39], a[84:87]
    ds_read_b64_tr_b16 v[108:109], v5 offset:36864
    v_mfma_f32_16x16x32_bf16 a[88:91], v[56:59], v[36:39], a[88:91]
    v_mfma_f32_16x16x32_bf16 a[92:95], v[60:63], v[36:39], a[92:95]
    ds_read_b128 v[36:39], v7 offset:38912
    s_waitcnt lgkmcnt(12)
    v_mfma_f32_16x16x32_bf16 a[96:99], v[48:51], v[40:43], a[96:99]
    ds_read_b64_tr_b16 v[110:111], v5 offset:37376
    v_mfma_f32_16x16x32_bf16 a[100:103], v[52:55], v[40:43], a[100:103]
    v_mfma_f32_16x16x32_bf16 a[104:107], v[56:59], v[40:43], a[104:107]
    v_mfma_f32_16x16x32_bf16 a[108:111], v[60:63], v[40:43], a[108:111]
    ds_read_b128 v[40:43], v7 offset:40960
    s_waitcnt lgkmcnt(13)
    v_mfma_f32_16x16x32_bf16 a[112:115], v[48:51], v[44:47], a[112:115]
    v_mfma_f32_16x16x32_bf16 a[116:119], v[52:55], v[44:47], a[116:119]
    v_mfma_f32_16x16x32_bf16 a[120:123], v[56:59], v[44:47], a[120:123]
    v_mfma_f32_16x16x32_bf16 a[124:127], v[60:63], v[44:47], a[124:127]
    ds_read_b128 v[44:47], v7 offset:43008
    s_waitcnt lgkmcnt(11)
    v_mfma_f32_16x16x32_bf16 a[0:3], v[64:67], v[24:27], a[0:3]
    v_mfma_f32_16x16x32_bf16 a[4:7], v[68:71], v[24:27], a[4:7]
    v_mfma_f32_16x16x32_bf16 a[8:11], v[72:75], v[24:27], a[8:11]
    v_mfma_f32_16x16x32_bf16 a[12:15], v[76:79], v[24:27], a[12:15]
    ds_read_b128 v[24:27], v7 offset:45056
    s_waitcnt lgkmcnt(9)
    v_mfma_f32_16x16x32_bf16 a[16:19], v[64:67], v[28:31], a[16:19]
    v_mfma_f32_16x16x32_bf16 a[20:23], v[68:71], v[28:31], a[20:23]
    v_mfma_f32_16x16x32_bf16 a[24:27], v[72:75], v[28:31], a[24:27]
    v_mfma_f32_16x16x32_bf16 a[28:31], v[76:79], v[28:31], a[28:31]
    ds_read_b128 v[28:31], v7 offset:47104
    s_waitcnt lgkmcnt(8)
    v_mfma_f32_16x16x32_bf16 a[32:35], v[64:67], v[32:35], a[32:35]
    v_mfma_f32_16x16x32_bf16 a[36:39], v[68:71], v[32:35], a[36:39]
    v_mfma_f32_16x16x32_bf16 a[40:43], v[72:75], v[32:35], a[40:43]
    v_mfma_f32_16x16x32_bf16 a[44:47], v[76:79], v[32:35], a[44:47]
    s_waitcnt lgkmcnt(4)
    s_barrier
    ds_read_b128 v[32:35], v6 offset:49152
    v_mfma_f32_16x16x32_bf16 a[48:51], v[64:67], v[36:39], a[48:51]
    v_add_u32 v2, 4294934528, v2
    v_add_u32 v3, 4294934528, v3
    v_add_u32 v4, 4294934528, v4
    v_add_u32 v5, 4294934528, v5
    v_mfma_f32_16x16x32_bf16 a[52:55], v[68:71], v[36:39], a[52:55]
    ds_read_b64_tr_b16 v[112:113], v2 offset:0
    v_mfma_f32_16x16x32_bf16 a[56:59], v[72:75], v[36:39], a[56:59]
    ds_read_b64_tr_b16 v[114:115], v2 offset:512
    v_mfma_f32_16x16x32_bf16 a[60:63], v[76:79], v[36:39], a[60:63]
    ds_read_b128 v[36:39], v7 offset:49152
    s_waitcnt lgkmcnt(7)
    v_mfma_f32_16x16x32_bf16 a[64:67], v[64:67], v[40:43], a[64:67]
    ds_read_b64_tr_b16 v[116:117], v3 offset:0
    v_mfma_f32_16x16x32_bf16 a[68:71], v[68:71], v[40:43], a[68:71]
    ds_read_b64_tr_b16 v[118:119], v3 offset:512
    v_mfma_f32_16x16x32_bf16 a[72:75], v[72:75], v[40:43], a[72:75]
    ds_read_b64_tr_b16 v[120:121], v4 offset:0
    v_mfma_f32_16x16x32_bf16 a[76:79], v[76:79], v[40:43], a[76:79]
    ds_read_b128 v[40:43], v8 offset:0
    s_waitcnt lgkmcnt(10)
    v_mfma_f32_16x16x32_bf16 a[80:83], v[64:67], v[44:47], a[80:83]
    ds_read_b64_tr_b16 v[122:123], v4 offset:512
    v_mfma_f32_16x16x32_bf16 a[84:87], v[68:71], v[44:47], a[84:87]
    ds_read_b64_tr_b16 v[124:125], v5 offset:0
    v_mfma_f32_16x16x32_bf16 a[88:91], v[72:75], v[44:47], a[88:91]
    ds_read_b64_tr_b16 v[126:127], v5 offset:512
    v_mfma_f32_16x16x32_bf16 a[92:95], v[76:79], v[44:47], a[92:95]
    ds_read_b128 v[44:47], v6 offset:51200
    s_waitcnt lgkmcnt(13)
    v_mfma_f32_16x16x32_bf16 a[96:99], v[64:67], v[24:27], a[96:99]
    s_waitcnt vmcnt(0)
L_rc_4:
    v_readfirstlane_b32 s45, v12
    s_nop 3
    s_cmp_eq_u32 s45, 8
    s_cbranch_scc1 L_rcok_5
    s_sleep 2
    buffer_load_dword v12, v10, s[60:63], s46 offen sc1
    s_waitcnt vmcnt(0)
    s_branch L_rc_4
L_rcok_5:
    v_mfma_f32_16x16x32_bf16 a[100:103], v[68:71], v[24:27], a[100:103]
    v_mfma_f32_16x16x32_bf16 a[104:107], v[72:75], v[24:27], a[104:107]
    v_mfma_f32_16x16x32_bf16 a[108:111], v[76:79], v[24:27], a[108:111]
    ds_read_b128 v[24:27], v7 offset:51200
    s_waitcnt lgkmcnt(13)
    v_mfma_f32_16x16x32_bf16 a[112:115], v[64:67], v[28:31], a[112:115]
    v_mfma_f32_16x16x32_bf16 a[116:119], v[68:71], v[28:31], a[116:119]
    v_mfma_f32_16x16x32_bf16 a[120:123], v[72:75], v[28:31], a[120:123]
    v_mfma_f32_16x16x32_bf16 a[124:127], v[76:79], v[28:31], a[124:127]
    ds_read_b128 v[28:31], v8 offset:2048
    s_waitcnt lgkmcnt(13)
    v_mfma_f32_16x16x32_bf16 a[0:3], v[80:83], v[32:35], a[0:3]
    v_mfma_f32_16x16x32_bf16 a[4:7], v[84:87], v[32:35], a[4:7]
    v_mfma_f32_16x16x32_bf16 a[8:11], v[88:91], v[32:35], a[8:11]
    v_mfma_f32_16x16x32_bf16 a[12:15], v[92:95], v[32:35], a[12:15]
    ds_read_b128 v[32:35], v6 offset:53248
    s_waitcnt lgkmcnt(11)
    v_mfma_f32_16x16x32_bf16 a[0:3], v[96:99], v[36:39], a[0:3]
    v_mfma_f32_16x16x32_bf16 a[4:7], v[100:103], v[36:39], a[4:7]
    v_mfma_f32_16x16x32_bf16 a[8:11], v[104:107], v[36:39], a[8:11]
    v_mfma_f32_16x16x32_bf16 a[12:15], v[108:111], v[36:39], a[12:15]
    ds_read_b128 v[36:39], v7 offset:53248
    s_waitcnt lgkmcnt(8)
    v_mfma_f32_16x16x32_bf16 a[0:3], v[112:115], v[40:43], a[0:3]
    v_mfma_f32_16x16x32_bf16 a[4:7], v[116:119], v[40:43], a[4:7]
    s_waitcnt lgkmcnt(7)
    v_mfma_f32_16x16x32_bf16 a[8:11], v[120:123], v[40:43], a[8:11]
    s_waitcnt lgkmcnt(5)
    v_mfma_f32_16x16x32_bf16 a[12:15], v[124:127], v[40:43], a[12:15]
    ds_read_b128 v[40:43], v8 offset:4096
    s_waitcnt lgkmcnt(5)
    v_mfma_f32_16x16x32_bf16 a[16:19], v[80:83], v[44:47], a[16:19]
    v_mfma_f32_16x16x32_bf16 a[20:23], v[84:87], v[44:47], a[20:23]
    v_mfma_f32_16x16x32_bf16 a[24:27], v[88:91], v[44:47], a[24:27]
    v_mfma_f32_16x16x32_bf16 a[28:31], v[92:95], v[44:47], a[28:31]
    ds_read_b128 v[44:47], v6 offset:55296
    s_waitcnt lgkmcnt(5)
    v_mfma_f32_16x16x32_bf16 a[16:19], v[96:99], v[24:27], a[16:19]
    s_add_u32 s47, s31, 1
    s_and_b32 s47, s47, 7
    s_lshl_b32 s47, s47, 16
    s_add_u32 s47, s47, s64
    v_accvgpr_read_b32 v13, a0
    v_accvgpr_read_b32 v14, a1
    v_cvt_pk_bf16_f32 v16, v13, v14
    v_mfma_f32_16x16x32_bf16 a[20:23], v[100:103], v[24:27], a[20:23]
    v_accvgpr_read_b32 v13, a2
    v_accvgpr_read_b32 v14, a3
    v_cvt_pk_bf16_f32 v17, v13, v14
    v_accvgpr_read_b32 v13, a4
    v_accvgpr_read_b32 v14, a5
    v_cvt_pk_bf16_f32 v18, v13, v14
    v_mfma_f32_16x16x32_bf16 a[24:27], v[104:107], v[24:27], a[24:27]
    v_accvgpr_read_b32 v13, a6
    v_accvgpr_read_b32 v14, a7
    v_cvt_pk_bf16_f32 v19, v13, v14
    buffer_store_dwordx4 v[16:19], v9, s[24:27], s47 offen offset:0 sc1
    v_mfma_f32_16x16x32_bf16 a[28:31], v[108:111], v[24:27], a[28:31]
    ds_read_b128 v[24:27], v7 offset:55296
    s_waitcnt lgkmcnt(5)
    v_mfma_f32_16x16x32_bf16 a[16:19], v[112:115], v[28:31], a[16:19]
    v_accvgpr_read_b32 v13, a8
    v_accvgpr_read_b32 v14, a9
    v_cvt_pk_bf16_f32 v20, v13, v14
    v_accvgpr_read_b32 v13, a10
    v_accvgpr_read_b32 v14, a11
    v_cvt_pk_bf16_f32 v21, v13, v14
    v_mfma_f32_16x16x32_bf16 a[20:23], v[116:119], v[28:31], a[20:23]
    v_accvgpr_read_b32 v13, a12
    v_accvgpr_read_b32 v14, a13
    v_cvt_pk_bf16_f32 v22, v13, v14
    v_accvgpr_read_b32 v13, a14
    v_accvgpr_read_b32 v14, a15
    v_cvt_pk_bf16_f32 v23, v13, v14
    v_mfma_f32_16x16x32_bf16 a[24:27], v[120:123], v[28:31], a[24:27]
    buffer_store_dwordx4 v[20:23], v9, s[24:27], s47 offen offset:1024 sc1
    v_mfma_f32_16x16x32_bf16 a[28:31], v[124:127], v[28:31], a[28:31]
    ds_read_b128 v[28:31], v8 offset:6144
    s_waitcnt lgkmcnt(5)
    v_mfma_f32_16x16x32_bf16 a[32:35], v[80:83], v[32:35], a[32:35]
    v_mfma_f32_16x16x32_bf16 a[36:39], v[84:87], v[32:35], a[36:39]
    v_mfma_f32_16x16x32_bf16 a[40:43], v[88:91], v[32:35], a[40:43]
    v_mfma_f32_16x16x32_bf16 a[44:47], v[92:95], v[32:35], a[44:47]
    ds_read_b128 v[32:35], v6 offset:57344
    s_waitcnt lgkmcnt(5)
    v_mfma_f32_16x16x32_bf16 a[32:35], v[96:99], v[36:39], a[32:35]
    s_add_u32 s47, s31, 2
    s_and_b32 s47, s47, 7
    s_lshl_b32 s47, s47, 16
    s_add_u32 s47, s47, s64
    v_accvgpr_read_b32 v13, a16
    v_accvgpr_read_b32 v14, a17
    v_cvt_pk_bf16_f32 v16, v13, v14
    v_mfma_f32_16x16x32_bf16 a[36:39], v[100:103], v[36:39], a[36:39]
    v_accvgpr_read_b32 v13, a18
    v_accvgpr_read_b32 v14, a19
    v_cvt_pk_bf16_f32 v17, v13, v14
    v_accvgpr_read_b32 v13, a20
    v_accvgpr_read_b32 v14, a21
    v_cvt_pk_bf16_f32 v18, v13, v14
    v_mfma_f32_16x16x32_bf16 a[40:43], v[104:107], v[36:39], a[40:43]
    v_accvgpr_read_b32 v13, a22
    v_accvgpr_read_b32 v14, a23
    v_cvt_pk_bf16_f32 v19, v13, v14
    buffer_store_dwordx4 v[16:19], v9, s[24:27], s47 offen offset:0 sc1
    v_mfma_f32_16x16x32_bf16 a[44:47], v[108:111], v[36:39], a[44:47]
    ds_read_b128 v[36:39], v7 offset:57344
    s_waitcnt lgkmcnt(5)
    v_mfma_f32_16x16x32_bf16 a[32:35], v[112:115], v[40:43], a[32:35]
    v_accvgpr_read_b32 v13, a24
    v_accvgpr_read_b32 v14, a25
    v_cvt_pk_bf16_f32 v20, v13, v14
    v_accvgpr_read_b32 v13, a26
    v_accvgpr_read_b32 v14, a27
    v_cvt_pk_bf16_f32 v21, v13, v14
    v_mfma_f32_16x16x32_bf16 a[36:39], v[116:119], v[40:43], a[36:39]
    v_accvgpr_read_b32 v13, a28
    v_accvgpr_read_b32 v14, a29
    v_cvt_pk_bf16_f32 v22, v13, v14
    v_accvgpr_read_b32 v13, a30
    v_accvgpr_read_b32 v14, a31
    v_cvt_pk_bf16_f32 v23, v13, v14
    v_mfma_f32_16x16x32_bf16 a[40:43], v[120:123], v[40:43], a[40:43]
    buffer_store_dwordx4 v[20:23], v9, s[24:27], s47 offen offset:1024 sc1
    v_mfma_f32_16x16x32_bf16 a[44:47], v[124:127], v[40:43], a[44:47]
    ds_read_b128 v[40:43], v8 offset:8192
    s_waitcnt lgkmcnt(5)
    v_mfma_f32_16x16x32_bf16 a[48:51], v[80:83], v[44:47], a[48:51]
    v_mfma_f32_16x16x32_bf16 a[52:55], v[84:87], v[44:47], a[52:55]
    v_mfma_f32_16x16x32_bf16 a[56:59], v[88:91], v[44:47], a[56:59]
    v_mfma_f32_16x16x32_bf16 a[60:63], v[92:95], v[44:47], a[60:63]
    ds_read_b128 v[44:47], v6 offset:59392
    s_waitcnt lgkmcnt(5)
    v_mfma_f32_16x16x32_bf16 a[48:51], v[96:99], v[24:27], a[48:51]
    s_add_u32 s47, s31, 3
    s_and_b32 s47, s47, 7
    s_lshl_b32 s47, s47, 16
    s_add_u32 s47, s47, s64
    v_accvgpr_read_b32 v13, a32
    v_accvgpr_read_b32 v14, a33
    v_cvt_pk_bf16_f32 v16, v13, v14
    v_mfma_f32_16x16x32_bf16 a[52:55], v[100:103], v[24:27], a[52:55]
    v_accvgpr_read_b32 v13, a34
    v_accvgpr_read_b32 v14, a35
    v_cvt_pk_bf16_f32 v17, v13, v14
    v_accvgpr_read_b32 v13, a36
    v_accvgpr_read_b32 v14, a37
    v_cvt_pk_bf16_f32 v18, v13, v14
    v_mfma_f32_16x16x32_bf16 a[56:59], v[104:107], v[24:27], a[56:59]
    v_accvgpr_read_b32 v13, a38
    v_accvgpr_read_b32 v14, a39
    v_cvt_pk_bf16_f32 v19, v13, v14
    buffer_store_dwordx4 v[16:19], v9, s[24:27], s47 offen offset:0 sc1
    v_mfma_f32_16x16x32_bf16 a[60:63], v[108:111], v[24:27], a[60:63]
    ds_read_b128 v[24:27], v7 offset:59392
    s_waitcnt lgkmcnt(5)
    v_mfma_f32_16x16x32_bf16 a[48:51], v[112:115], v[28:31], a[48:51]
    v_accvgpr_read_b32 v13, a40
    v_accvgpr_read_b32 v14, a41
    v_cvt_pk_bf16_f32 v20, v13, v14
    v_accvgpr_read_b32 v13, a42
    v_accvgpr_read_b32 v14, a43
    v_cvt_pk_bf16_f32 v21, v13, v14
    v_mfma_f32_16x16x32_bf16 a[52:55], v[116:119], v[28:31], a[52:55]
    v_accvgpr_read_b32 v13, a44
    v_accvgpr_read_b32 v14, a45
    v_cvt_pk_bf16_f32 v22, v13, v14
    v_accvgpr_read_b32 v13, a46
    v_accvgpr_read_b32 v14, a47
    v_cvt_pk_bf16_f32 v23, v13, v14
    v_mfma_f32_16x16x32_bf16 a[56:59], v[120:123], v[28:31], a[56:59]
    buffer_store_dwordx4 v[20:23], v9, s[24:27], s47 offen offset:1024 sc1
    v_mfma_f32_16x16x32_bf16 a[60:63], v[124:127], v[28:31], a[60:63]
    ds_read_b128 v[28:31], v8 offset:10240
    s_waitcnt lgkmcnt(5)
    v_mfma_f32_16x16x32_bf16 a[64:67], v[80:83], v[32:35], a[64:67]
    v_mfma_f32_16x16x32_bf16 a[68:71], v[84:87], v[32:35], a[68:71]
    v_mfma_f32_16x16x32_bf16 a[72:75], v[88:91], v[32:35], a[72:75]
    v_mfma_f32_16x16x32_bf16 a[76:79], v[92:95], v[32:35], a[76:79]
    ds_read_b128 v[32:35], v6 offset:61440
    s_waitcnt lgkmcnt(5)
    v_mfma_f32_16x16x32_bf16 a[64:67], v[96:99], v[36:39], a[64:67]
    s_add_u32 s47, s31, 4
    s_and_b32 s47, s47, 7
    s_lshl_b32 s47, s47, 16
    s_add_u32 s47, s47, s64
    v_accvgpr_read_b32 v13, a48
    v_accvgpr_read_b32 v14, a49
    v_cvt_pk_bf16_f32 v16, v13, v14
    v_mfma_f32_16x16x32_bf16 a[68:71], v[100:103], v[36:39], a[68:71]
    v_accvgpr_read_b32 v13, a50
    v_accvgpr_read_b32 v14, a51
    v_cvt_pk_bf16_f32 v17, v13, v14
    v_accvgpr_read_b32 v13, a52
    v_accvgpr_read_b32 v14, a53
    v_cvt_pk_bf16_f32 v18, v13, v14
    v_mfma_f32_16x16x32_bf16 a[72:75], v[104:107], v[36:39], a[72:75]
    v_accvgpr_read_b32 v13, a54
    v_accvgpr_read_b32 v14, a55
    v_cvt_pk_bf16_f32 v19, v13, v14
    buffer_store_dwordx4 v[16:19], v9, s[24:27], s47 offen offset:0 sc1
    v_mfma_f32_16x16x32_bf16 a[76:79], v[108:111], v[36:39], a[76:79]
    ds_read_b128 v[36:39], v7 offset:61440
    s_waitcnt lgkmcnt(5)
    v_mfma_f32_16x16x32_bf16 a[64:67], v[112:115], v[40:43], a[64:67]
    v_accvgpr_read_b32 v13, a56
    v_accvgpr_read_b32 v14, a57
    v_cvt_pk_bf16_f32 v20, v13, v14
    v_accvgpr_read_b32 v13, a58
    v_accvgpr_read_b32 v14, a59
    v_cvt_pk_bf16_f32 v21, v13, v14
    v_mfma_f32_16x16x32_bf16 a[68:71], v[116:119], v[40:43], a[68:71]
    v_accvgpr_read_b32 v13, a60
    v_accvgpr_read_b32 v14, a61
    v_cvt_pk_bf16_f32 v22, v13, v14
    v_accvgpr_read_b32 v13, a62
    v_accvgpr_read_b32 v14, a63
    v_cvt_pk_bf16_f32 v23, v13, v14
    v_mfma_f32_16x16x32_bf16 a[72:75], v[120:123], v[40:43], a[72:75]
    buffer_store_dwordx4 v[20:23], v9, s[24:27], s47 offen offset:1024 sc1
    v_mfma_f32_16x16x32_bf16 a[76:79], v[124:127], v[40:43], a[76:79]
    ds_read_b128 v[40:43], v8 offset:12288
    s_waitcnt lgkmcnt(5)
    v_mfma_f32_16x16x32_bf16 a[80:83], v[80:83], v[44:47], a[80:83]
    v_mfma_f32_16x16x32_bf16 a[84:87], v[84:87], v[44:47], a[84:87]
    v_mfma_f32_16x16x32_bf16 a[88:91], v[88:91], v[44:47], a[88:91]
    v_mfma_f32_16x16x32_bf16 a[92:95], v[92:95], v[44:47], a[92:95]
    ds_read_b128 v[44:47], v6 offset:63488
    s_waitcnt lgkmcnt(5)
    v_mfma_f32_16x16x32_bf16 a[80:83], v[96:99], v[24:27], a[80:83]
    s_add_u32 s47, s31, 5
    s_and_b32 s47, s47, 7
    s_lshl_b32 s47, s47, 16
    s_add_u32 s47, s47, s64
    v_accvgpr_read_b32 v13, a64
    v_accvgpr_read_b32 v14, a65
    v_cvt_pk_bf16_f32 v16, v13, v14
    v_mfma_f32_16x16x32_bf16 a[84:87], v[100:103], v[24:27], a[84:87]
    v_accvgpr_read_b32 v13, a66
    v_accvgpr_read_b32 v14, a67
    v_cvt_pk_bf16_f32 v17, v13, v14
    v_accvgpr_read_b32 v13, a68
    v_accvgpr_read_b32 v14, a69
    v_cvt_pk_bf16_f32 v18, v13, v14
    v_mfma_f32_16x16x32_bf16 a[88:91], v[104:107], v[24:27], a[88:91]
    v_accvgpr_read_b32 v13, a70
    v_accvgpr_read_b32 v14, a71
    v_cvt_pk_bf16_f32 v19, v13, v14
    buffer_store_dwordx4 v[16:19], v9, s[24:27], s47 offen offset:0 sc1
    v_mfma_f32_16x16x32_bf16 a[92:95], v[108:111], v[24:27], a[92:95]
    ds_read_b128 v[24:27], v7 offset:63488
    s_waitcnt lgkmcnt(5)
    v_mfma_f32_16x16x32_bf16 a[80:83], v[112:115], v[28:31], a[80:83]
    v_accvgpr_read_b32 v13, a72
    v_accvgpr_read_b32 v14, a73
    v_cvt_pk_bf16_f32 v20, v13, v14
    v_accvgpr_read_b32 v13, a74
    v_accvgpr_read_b32 v14, a75
    v_cvt_pk_bf16_f32 v21, v13, v14
    v_mfma_f32_16x16x32_bf16 a[84:87], v[116:119], v[28:31], a[84:87]
    v_accvgpr_read_b32 v13, a76
    v_accvgpr_read_b32 v14, a77
    v_cvt_pk_bf16_f32 v22, v13, v14
    v_accvgpr_read_b32 v13, a78
    v_accvgpr_read_b32 v14, a79
    v_cvt_pk_bf16_f32 v23, v13, v14
    v_mfma_f32_16x16x32_bf16 a[88:91], v[120:123], v[28:31], a[88:91]
    buffer_store_dwordx4 v[20:23], v9, s[24:27], s47 offen offset:1024 sc1
    v_mfma_f32_16x16x32_bf16 a[92:95], v[124:127], v[28:31], a[92:95]
    ds_read_b128 v[28:31], v8 offset:14336
    s_waitcnt lgkmcnt(5)
    v_mfma_f32_16x16x32_bf16 a[96:99], v[80:83], v[32:35], a[96:99]
    v_mfma_f32_16x16x32_bf16 a[100:103], v[84:87], v[32:35], a[100:103]
    v_mfma_f32_16x16x32_bf16 a[104:107], v[88:91], v[32:35], a[104:107]
    v_mfma_f32_16x16x32_bf16 a[108:111], v[92:95], v[32:35], a[108:111]
    s_waitcnt lgkmcnt(4)
    v_mfma_f32_16x16x32_bf16 a[96:99], v[96:99], v[36:39], a[96:99]
    s_add_u32 s47, s31, 6
    s_and_b32 s47, s47, 7
    s_lshl_b32 s47, s47, 16
    s_add_u32 s47, s47, s64
    v_accvgpr_read_b32 v13, a80
    v_accvgpr_read_b32 v14, a81
    v_cvt_pk_bf16_f32 v16, v13, v14
    v_mfma_f32_16x16x32_bf16 a[100:103], v[100:103], v[36:39], a[100:103]
    v_accvgpr_read_b32 v13, a82
    v_accvgpr_read_b32 v14, a83
    v_cvt_pk_bf16_f32 v17, v13, v14
    v_accvgpr_read_b32 v13, a84
    v_accvgpr_read_b32 v14, a85
    v_cvt_pk_bf16_f32 v18, v13, v14
    v_mfma_f32_16x16x32_bf16 a[104:107], v[104:107], v[36:39], a[104:107]
    v_accvgpr_read_b32 v13, a86
    v_accvgpr_read_b32 v14, a87
    v_cvt_pk_bf16_f32 v19, v13, v14
    buffer_store_dwordx4 v[16:19], v9, s[24:27], s47 offen offset:0 sc1
    v_mfma_f32_16x16x32_bf16 a[108:111], v[108:111], v[36:39], a[108:111]
    s_waitcnt lgkmcnt(3)
    v_mfma_f32_16x16x32_bf16 a[96:99], v[112:115], v[40:43], a[96:99]
    v_accvgpr_read_b32 v13, a88
    v_accvgpr_read_b32 v14, a89
    v_cvt_pk_bf16_f32 v20, v13, v14
    v_accvgpr_read_b32 v13, a90
    v_accvgpr_read_b32 v14, a91
    v_cvt_pk_bf16_f32 v21, v13, v14
    v_mfma_f32_16x16x32_bf16 a[100:103], v[116:119], v[40:43], a[100:103]
    v_accvgpr_read_b32 v13, a92
    v_accvgpr_read_b32 v14, a93
    v_cvt_pk_bf16_f32 v22, v13, v14
    v_accvgpr_read_b32 v13, a94
    v_accvgpr_read_b32 v14, a95
    v_cvt_pk_bf16_f32 v23, v13, v14
    v_mfma_f32_16x16x32_bf16 a[104:107], v[120:123], v[40:43], a[104:107]
    buffer_store_dwordx4 v[20:23], v9, s[24:27], s47 offen offset:1024 sc1
    v_mfma_f32_16x16x32_bf16 a[108:111], v[124:127], v[40:43], a[108:111]
    s_waitcnt lgkmcnt(2)
    v_mfma_f32_16x16x32_bf16 a[112:115], v[80:83], v[44:47], a[112:115]
    v_mfma_f32_16x16x32_bf16 a[116:119], v[84:87], v[44:47], a[116:119]
    v_mfma_f32_16x16x32_bf16 a[120:123], v[88:91], v[44:47], a[120:123]
    v_mfma_f32_16x16x32_bf16 a[124:127], v[92:95], v[44:47], a[124:127]
    s_waitcnt lgkmcnt(1)
    v_mfma_f32_16x16x32_bf16 a[112:115], v[96:99], v[24:27], a[112:115]
    s_add_u32 s47, s31, 7
    s_and_b32 s47, s47, 7
    s_lshl_b32 s47, s47, 16
    s_add_u32 s47, s47, s64
    v_accvgpr_read_b32 v13, a96
    v_accvgpr_read_b32 v14, a97
    v_cvt_pk_bf16_f32 v16, v13, v14
    v_mfma_f32_16x16x32_bf16 a[116:119], v[100:103], v[24:27], a[116:119]
    v_accvgpr_read_b32 v13, a98
    v_accvgpr_read_b32 v14, a99
    v_cvt_pk_bf16_f32 v17, v13, v14
    v_accvgpr_read_b32 v13, a100
    v_accvgpr_read_b32 v14, a101
    v_cvt_pk_bf16_f32 v18, v13, v14
    v_mfma_f32_16x16x32_bf16 a[120:123], v[104:107], v[24:27], a[120:123]
    v_accvgpr_read_b32 v13, a102
    v_accvgpr_read_b32 v14, a103
    v_cvt_pk_bf16_f32 v19, v13, v14
    buffer_store_dwordx4 v[16:19], v9, s[24:27], s47 offen offset:0 sc1
    v_mfma_f32_16x16x32_bf16 a[124:127], v[108:111], v[24:27], a[124:127]
    s_waitcnt lgkmcnt(0)
    v_mfma_f32_16x16x32_bf16 a[112:115], v[112:115], v[28:31], a[112:115]
    v_accvgpr_read_b32 v13, a104
    v_accvgpr_read_b32 v14, a105
    v_cvt_pk_bf16_f32 v20, v13, v14
    v_accvgpr_read_b32 v13, a106
    v_accvgpr_read_b32 v14, a107
    v_cvt_pk_bf16_f32 v21, v13, v14
    v_mfma_f32_16x16x32_bf16 a[116:119], v[116:119], v[28:31], a[116:119]
    v_accvgpr_read_b32 v13, a108
    v_accvgpr_read_b32 v14, a109
    v_cvt_pk_bf16_f32 v22, v13, v14
    v_accvgpr_read_b32 v13, a110
    v_accvgpr_read_b32 v14, a111
    v_cvt_pk_bf16_f32 v23, v13, v14
    v_mfma_f32_16x16x32_bf16 a[120:123], v[120:123], v[28:31], a[120:123]
    buffer_store_dwordx4 v[20:23], v9, s[24:27], s47 offen offset:1024 sc1
    v_mfma_f32_16x16x32_bf16 a[124:127], v[124:127], v[28:31], a[124:127]
    s_lshl_b32 s45, s30, 13
    s_add_u32 s45, s45, 65536
    v_add_u32 v13, s45, v9
    s_nop 7
    ds_write_b128 v13, a[112:115] offset:0
    ds_write_b128 v13, a[116:119] offset:1024
    ds_write_b128 v13, a[120:123] offset:2048
    ds_write_b128 v13, a[124:127] offset:3072
    s_bitcmp1_b32 s49, 0
    s_cbranch_scc1 L_of_6
    s_waitcnt vmcnt(12)
    s_bitset1_b32 s49, 0
    s_mov_b64 exec, 1
    s_add_u32 s45, s31, 1
    s_and_b32 s45, s45, 7
    s_lshl_b32 s45, s45, 7
    s_add_u32 s45, s45, s65
    buffer_store_dword v11, v10, s[24:27], s45 offen sc1
    s_mov_b64 exec, -1
L_of_6:
    s_bitcmp1_b32 s49, 1
    s_cbranch_scc1 L_of_7
    s_waitcnt vmcnt(10)
    s_bitset1_b32 s49, 1
    s_mov_b64 exec, 1
    s_add_u32 s45, s31, 2
    s_and_b32 s45, s45, 7
    s_lshl_b32 s45, s45, 7
    s_add_u32 s45, s45, s65
    buffer_store_dword v11, v10, s[24:27], s45 offen sc1
    s_mov_b64 exec, -1
L_of_7:
    s_bitcmp1_b32 s49, 2
    s_cbranch_scc1 L_of_8
    s_waitcnt vmcnt(8)
    s_bitset1_b32 s49, 2
    s_mov_b64 exec, 1
    s_add_u32 s45, s31, 3
    s_and_b32 s45, s45, 7
    s_lshl_b32 s45, s45, 7
    s_add_u32 s45, s45, s65
    buffer_store_dword v11, v10, s[24:27], s45 offen sc1
    s_mov_b64 exec, -1
L_of_8:
    s_bitcmp1_b32 s49, 3
    s_cbranch_scc1 L_of_9
    s_waitcnt vmcnt(6)
    s_bitset1_b32 s49, 3
    s_mov_b64 exec, 1
    s_add_u32 s45, s31, 4
    s_and_b32 s45, s45, 7
    s_lshl_b32 s45, s45, 7
    s_add_u32 s45, s45, s65
    buffer_store_dword v11, v10, s[24:27], s45 offen sc1
    s_mov_b64 exec, -1
L_of_9:
    s_bitcmp1_b32 s49, 4
    s_cbranch_scc1 L_of_10
    s_waitcnt vmcnt(4)
    s_bitset1_b32 s49, 4
    s_mov_b64 exec, 1
    s_add_u32 s45, s31, 5
    s_and_b32 s45, s45, 7
    s_lshl_b32 s45, s45, 7
    s_add_u32 s45, s45, s65
    buffer_store_dword v11, v10, s[24:27], s45 offen sc1
    s_mov_b64 exec, -1
L_of_10:
    s_bitcmp1_b32 s49, 5
    s_cbranch_scc1 L_of_11
    s_waitcnt vmcnt(2)
    s_bitset1_b32 s49, 5
    s_mov_b64 exec, 1
    s_add_u32 s45, s31, 6
    s_and_b32 s45, s45, 7
    s_lshl_b32 s45, s45, 7
    s_add_u32 s45, s45, s65
    buffer_store_dword v11, v10, s[24:27], s45 offen sc1
    s_mov_b64 exec, -1
L_of_11:
    s_bitcmp1_b32 s49, 6
    s_cbranch_scc1 L_of_12
    s_waitcnt vmcnt(0)
    s_bitset1_b32 s49, 6
    s_mov_b64 exec, 1
    s_add_u32 s45, s31, 7
    s_and_b32 s45, s45, 7
    s_lshl_b32 s45, s45, 7
    s_add_u32 s45, s45, s65
    buffer_store_dword v11, v10, s[24:27], s45 offen sc1
    s_mov_b64 exec, -1
L_of_12:
    s_waitcnt lgkmcnt(0)
    s_barrier
L_end:
    s_endpgm
.section .rodata,"a"
.p2align 6
.amdhsa_kernel standalone__deep_cross_wide_deep__recsys_kernel
  .amdhsa_next_free_vgpr 256
  .amdhsa_next_free_sgpr 102
  .amdhsa_accum_offset 128
  .amdhsa_group_segment_fixed_size 0
  .amdhsa_kernarg_size 96
  .amdhsa_user_sgpr_count 2
  .amdhsa_user_sgpr_kernarg_segment_ptr 1
  .amdhsa_system_sgpr_workgroup_id_x 1
.end_amdhsa_kernel
```
